```python
import torch

def _softmax(x, axis=-1):
    return torch.softmax(x, dim=axis)
def _gelu(x):
    return torch.nn.functional.gelu(x, approximate="tanh")
def _silu(x):
    return torch.nn.functional.silu(x)
def _sigmoid(x):
    return torch.sigmoid(x)
def _layernorm(x, axis=-1, eps=1e-5):
    m = x.mean(dim=axis, keepdim=True)
    v = x.var(dim=axis, keepdim=True, unbiased=False)
    return (x - m) / torch.sqrt(v + eps)
def _scatter_add(tgt, idx, src, axis=0):
    return tgt.clone().index_add_(axis, idx, src)
def _segment_sum(src, seg, n):
    out = torch.zeros((n,) + src.shape[1:], dtype=src.dtype)
    return out.index_add_(0, seg, src)
def _pad(x, pw):
    flat = tuple(v for pair in reversed(pw) for v in pair)
    return torch.nn.functional.pad(x, flat)

kernel_name = 'standalone__dense_activation_mish__prompt'

def setup_inputs():

    _w = (lambda a: (lambda t: t.to(torch.bfloat16) if t.is_floating_point() else t)(torch.as_tensor(a)))
    B, S, D, F = 1, 2048, 512, 1792
    return {
        "x": _w((lambda *s: torch.randn(*s, dtype=torch.bfloat16) * 0.05)(B, S, D)),
        "w1": _w((lambda *s: torch.randn(*s, dtype=torch.bfloat16) * 3.2)(D, F) * (D ** -0.5)),
        "b1": _w((lambda *s: torch.randn(*s, dtype=torch.bfloat16) * 0.05)(F)),
        "w2": _w((lambda *s: torch.randn(*s, dtype=torch.bfloat16) * 0.05)(F, D) * (F ** -0.5)),
    }

def reference(x, w1, b1, w2):
    h = torch.einsum("bsd,df->bsf", x, w1) + b1
    sp = torch.log1p(torch.exp(-torch.abs(h))) + torch.where(h > 0, h, torch.zeros_like(h))
    act = h * torch.tanh(sp)
    return torch.einsum("bsf,fd->bsd", act, w2)
```

```asm
; @launch grid=(256,1,1) block=(256,1,1) lds=163840
.amdgcn_target "amdgcn-amd-amdhsa--gfx950"
.text
.globl standalone__dense_activation_mish__prompt_kernel
.p2align 8
.type standalone__dense_activation_mish__prompt_kernel,@function
standalone__dense_activation_mish__prompt_kernel:
    s_load_dwordx2 s[20:21], s[0:1], 0
    s_load_dwordx2 s[24:25], s[0:1], 8
    s_load_dwordx2 s[28:29], s[0:1], 16
    s_load_dwordx8 s[8:15], s[0:1], 24
    s_cmpk_ge_u32 s2, 256
    s_cbranch_scc1 L_end
    v_lshrrev_b32 v38, 6, v0
    v_and_b32 v1, 63, v0
    v_readfirstlane_b32 s3, v38
    s_bfe_u32 s47, s2, 0x30003
    s_mov_b32 s23, 0x20000
    s_cmp_lg_u32 s47, 7
    s_cbranch_scc1 L_go
    s_getpc_b64 s[4:5]
L_pcref:
    v_lshlrev_b32 v48, 6, v0
    v_add_co_u32 v48, vcc, s4, v48
    v_mov_b32 v49, s5
    s_nop 0
    v_addc_co_u32 v49, vcc, 0, v49, vcc
    global_load_dword v62, v[48:49], off
    s_branch L_spare
L_go:
    s_and_b32 s46, s2, 1
    s_lshr_b32 s49, s2, 6
    s_and_b32 s44, s2, 6
    s_lshl1_add_u32 s44, s44, s49
    s_lshl_b32 s58, s3, 12
    v_lshrrev_b32 v38, 3, v1
    v_lshrrev_b32 v39, 4, v1
    v_and_b32 v40, 7, v1
    s_lshl_b32 s22, s23, 4
    s_and_b32 s62, s3, 2
    s_add_u32 s62, s62, s3
    s_lshl3_add_u32 s54, s44, s62
    s_lshl_b32 s54, s54, 14
    s_mul_i32 s45, s46, 7
    s_add_u32 s45, s45, s47
    s_add_u32 s62, s49, s47
    s_and_b32 s62, s62, 1
    s_lshr_b32 s63, s2, 1
    s_xor_b32 s63, s63, s2
    s_and_b32 s63, s63, 1
    s_lshl1_add_u32 s62, s62, s63
    s_lshl_b32 s61, s62, 1
    s_mul_i32 s55, s3, 224
    s_add_u32 s55, s55, s45
    s_lshl_b32 s55, s55, 8
    v_xor_b32 v41, v40, v39
    v_lshlrev_b32 v41, 4, v41
    v_lshl_add_u32 v2, v38, 10, v41
    v_xor_b32 v41, 64, v2
    v_add_u32 v3, 7168, v41
    v_and_b32 v46, 15, v1
    v_lshlrev_b32 v42, 2, v39
    v_xor_b32 v41, v46, v42
    v_mul_u32_u24 v42, 224, v39
    v_add_lshl_u32 v6, v42, v41, 4
    v_add_u32 v7, 13312, v6
    v_add_u32 v8, 26624, v6
    v_add_u32 v9, 39936, v6
    s_mul_i32 s26, s23, 14
    s_mov_b32 s27, s23
    s_add_u32 m0, s58, 49152
    s_lshl_b32 s56, s61, 7
    s_add_u32 s56, s56, s54
    s_waitcnt lgkmcnt(0)
    buffer_load_dwordx4 v2, s[20:23], s56 offen offset:0 lds
    buffer_load_dwordx4 v3, s[20:23], s56 offen offset:1024 lds
    s_mov_b32 m0, s58
    s_mul_i32 s57, s61, 229376
    s_add_u32 s57, s57, s55
    buffer_load_dwordx4 v6, s[24:27], s57 offen offset:0 lds
    buffer_load_dwordx4 v7, s[24:27], s57 offen offset:1024 lds
    buffer_load_dwordx4 v8, s[24:27], s57 offen offset:2048 lds
    s_movk_i32 s30, 3584
    s_mov_b32 s31, s23
    v_lshlrev_b32 v31, 1, v1
    s_lshr_b32 s18, s3, 1
    s_lshl1_add_u32 s18, s45, s18
    s_lshl_b32 s18, s18, 7
    buffer_load_ushort v128, v31, s[28:31], s18 offen
    buffer_load_dwordx4 v9, s[24:27], s57 offen offset:3072 lds
    s_add_u32 m0, s58, 51200
    s_xor_b32 s61, s61, 1
    s_lshl_b32 s56, s61, 7
    s_add_u32 s56, s56, s54
    buffer_load_dwordx4 v2, s[20:23], s56 offen offset:0 lds
    buffer_load_dwordx4 v3, s[20:23], s56 offen offset:1024 lds
    s_add_u32 m0, s58, 16384
    s_mul_i32 s57, s61, 229376
    s_add_u32 s57, s57, s55
    buffer_load_dwordx4 v6, s[24:27], s57 offen offset:0 lds
    buffer_load_dwordx4 v7, s[24:27], s57 offen offset:1024 lds
    buffer_load_dwordx4 v8, s[24:27], s57 offen offset:2048 lds
    buffer_load_dwordx4 v9, s[24:27], s57 offen offset:3072 lds
    s_add_u32 m0, s58, 65536
    s_xor_b32 s61, s61, 3
    s_lshl_b32 s56, s61, 7
    s_add_u32 s56, s56, s54
    buffer_load_dwordx4 v2, s[20:23], s56 offen offset:0 lds
    buffer_load_dwordx4 v3, s[20:23], s56 offen offset:1024 lds
    s_add_u32 m0, s58, 32768
    s_mul_i32 s57, s61, 229376
    s_add_u32 s57, s57, s55
    buffer_load_dwordx4 v6, s[24:27], s57 offen offset:0 lds
    buffer_load_dwordx4 v7, s[24:27], s57 offen offset:1024 lds
    v_lshrrev_b32 v43, 5, v1
    v_and_b32 v41, 1, v39
    v_bfe_u32 v45, v1, 2, 2
    v_and_b32 v42, 3, v1
    v_lshlrev_b32 v42, 3, v42
    v_lshl_add_u32 v42, v41, 5, v42
    s_and_b32 s50, s3, 1
    s_lshr_b32 s51, s3, 1
    s_lshl_b32 s62, s50, 13
    s_add_u32 s62, s62, 49152
    v_lshl_add_u32 v46, v46, 7, s62
    v_lshl_add_u32 v46, v41, 12, v46
    v_bfe_u32 v47, v1, 1, 3
    v_xor_b32 v47, v47, v43
    v_lshl_add_u32 v14, v47, 4, v46
    v_xor_b32 v15, 32, v14
    v_xor_b32 v16, 64, v14
    v_xor_b32 v17, 96, v14
    v_lshl_add_u32 v47, v43, 3, v45
    v_lshl_add_u32 v47, v47, 8, v42
    s_and_b32 s62, s3, 2
    v_xor_b32 v44, s62, v45
    v_lshl_add_u32 v18, v44, 6, v47
    v_xor_b32 v19, 64, v18
    v_mul_u32_u24 v136, 0x3f80, v43
    v_xor_b32 v132, 0x3f80, v136
    v_mov_b32 v129, 0
    v_mov_b32 v130, 0
    v_mov_b32 v131, 0
    v_mov_b32 v133, 0
    v_mov_b32 v134, 0
    v_mov_b32 v135, 0
    v_mov_b32 v137, 0
    v_mov_b32 v138, 0
    v_mov_b32 v139, 0
    s_mov_b64 s[64:65], s[10:11]
    s_mov_b32 s10, 1835008
    s_mov_b32 s11, s23
    s_mov_b64 s[40:41], s[12:13]
    s_mov_b64 s[32:33], s[14:15]
    s_mov_b64 s[36:37], s[14:15]
    s_mov_b32 s34, 7602176
    s_mov_b32 s35, s23
    s_mov_b32 s38, s34
    s_mov_b32 s39, s23
    s_movk_i32 s42, 256
    s_mov_b32 s43, s23
    s_and_b32 s73, s2, 7
    s_xor_b32 s19, s47, 4
    s_lshl2_add_u32 s48, s73, s49
    v_lshlrev_b32 v46, 2, v41
    buffer_load_dwordx4 v8, s[24:27], s57 offen offset:2048 lds
    buffer_load_dwordx4 v9, s[24:27], s57 offen offset:3072 lds
    s_add_u32 m0, s58, 67584
    s_xor_b32 s61, s61, 1
    s_lshl_b32 s56, s61, 7
    s_add_u32 s56, s56, s54
    s_waitcnt vmcnt(12)
    s_barrier
    v_mfma_f32_32x32x16_bf16 v[64:79], v[128:131], v[132:135], 0
    ds_read_b128 v[160:163], v14 offset:0
    ds_read_b64_tr_b16 a[0:1], v18 offset:0
    ds_read_b64_tr_b16 a[2:3], v18 offset:1024
    ds_read_b64_tr_b16 a[4:5], v19 offset:0
    ds_read_b64_tr_b16 a[6:7], v19 offset:1024
    ds_read_b128 v[164:167], v15 offset:0
    ds_read_b64_tr_b16 a[8:9], v18 offset:4096
    ds_read_b64_tr_b16 a[10:11], v18 offset:5120
    ds_read_b64_tr_b16 a[12:13], v19 offset:4096
    ds_read_b64_tr_b16 a[14:15], v19 offset:5120
    v_mfma_f32_32x32x16_bf16 v[80:95], v[128:131], v[136:139], 0
    v_xor_b32 v46, v40, v46
    v_lshlrev_b32 v46, 4, v46
    v_lshl_add_u32 v10, v38, 10, v46
    v_add_u32 v11, 7168, v10
    v_add_u32 v12, 14336, v10
    v_add_u32 v13, 21504, v10
    v_lshl_add_u32 v47, v43, 2, v45
    v_mfma_f32_32x32x16_bf16 v[96:111], v[128:131], v[132:135], 0
    v_lshl_add_u32 v47, v47, 7, v42
    v_bfe_u32 v44, v1, 3, 1
    v_lshl_add_u32 v47, v44, 6, v47
    v_add_u32 v20, s58, v47
    v_xor_b32 v21, 64, v20
    v_add_u32 v22, 65536, v20
    v_add_u32 v23, 65536, v21
    v_mfma_f32_32x32x16_bf16 v[112:127], v[128:131], v[136:139], 0
    s_waitcnt lgkmcnt(7)
    v_mfma_f32_32x32x16_bf16 v[64:79], a[0:3], v[160:163], v[64:79]
    ds_read_b128 v[168:171], v16 offset:0
    ds_read_b64_tr_b16 a[16:17], v18 offset:8192
    ds_read_b64_tr_b16 a[18:19], v18 offset:9216
    v_add_u32 v35, 131072, v20
    v_add_u32 v36, 131072, v21
    v_lshlrev_b32 v24, 4, v1
    v_mov_b32 v29, 1
    v_lshlrev_b32 v30, 2, v1
    s_lshl1_add_u32 s62, s44, s46
    s_lshl_b32 s62, s62, 2
    buffer_load_dwordx4 v2, s[20:23], s56 offen offset:0 lds
    s_waitcnt lgkmcnt(8)
    v_mfma_f32_32x32x16_bf16 v[80:95], a[4:7], v[160:163], v[80:95]
    ds_read_b64_tr_b16 a[20:21], v19 offset:8192
    ds_read_b64_tr_b16 a[22:23], v19 offset:9216
    s_and_b32 s63, s48, 30
    s_add_u32 s63, s63, s51
    s_lshl_b32 s63, s63, 2
    s_sub_u32 s63, s63, s62
    v_mul_lo_u32 v26, v43, s63
    v_add_u32 v26, s62, v26
    v_and_b32 v46, 15, v1
    buffer_load_dwordx4 v3, s[20:23], s56 offen offset:1024 lds
    s_waitcnt lgkmcnt(7)
    v_mfma_f32_32x32x16_bf16 v[64:79], a[8:11], v[164:167], v[64:79]
    ds_read_b128 v[172:175], v17 offset:0
    ds_read_b64_tr_b16 a[24:25], v18 offset:12288
    ds_read_b64_tr_b16 a[26:27], v18 offset:13312
    v_lshl_add_u32 v46, v46, 8, s58
    v_lshl_add_u32 v46, v41, 14, v46
    v_xor_b32 v47, v40, v43
    v_lshl_add_u32 v32, v47, 4, v46
    s_lshl_b32 s62, s51, 14
    s_lshl_b32 s63, s50, 11
    s_add_u32 s62, s62, s63
    s_waitcnt lgkmcnt(8)
    v_mfma_f32_32x32x16_bf16 v[80:95], a[12:15], v[164:167], v[80:95]
    ds_read_b64_tr_b16 a[28:29], v19 offset:12288
    ds_read_b64_tr_b16 a[30:31], v19 offset:13312
    v_lshl_add_u32 v46, v38, 8, s62
    v_lshlrev_b32 v47, 1, v40
    v_xor_b32 v47, v47, v38
    v_lshl_add_u32 v33, v47, 4, v46
    v_lshlrev_b32 v46, 4, v40
    v_lshl_add_u32 v34, v38, 10, v46
    s_mul_i32 s79, s3, 3584
    s_waitcnt lgkmcnt(7)
    v_mfma_f32_32x32x16_bf16 v[64:79], a[16:19], v[168:171], v[64:79]
    s_waitcnt vmcnt(8)
    s_waitcnt lgkmcnt(0)
    s_barrier
    ds_read_b128 v[160:163], v14 offset:2048
    ds_read_b64_tr_b16 a[32:33], v18 offset:16384
    ds_read_b64_tr_b16 a[34:35], v18 offset:17408
    s_add_u32 s79, s79, s19
    s_lshl_b32 s79, s79, 7
    s_mul_i32 s62, s48, 237568
    s_mul_i32 s69, s3, 896
    s_add_u32 s69, s69, s62
    s_add_u32 s69, s69, 114688
    s_mul_i32 s70, s3, 28672
    s_mov_b32 m0, s58
    s_mul_i32 s57, s61, 229376
    s_add_u32 s57, s57, s55
    buffer_load_dwordx4 v6, s[24:27], s57 offen offset:0 lds
    v_mfma_f32_32x32x16_bf16 v[80:95], a[20:23], v[168:171], v[80:95]
    ds_read_b64_tr_b16 a[36:37], v19 offset:16384
    ds_read_b64_tr_b16 a[38:39], v19 offset:17408
    s_add_u32 s70, s70, s62
    s_lshl3_add_u32 s72, s48, s3
    s_lshl_b32 s72, s72, 6
    s_add_u32 s72, s72, s19
    s_lshl_b32 s72, s72, 7
    s_mov_b32 s71, 0
    s_lshl1_add_u32 s62, s44, s50
    buffer_load_dwordx4 v7, s[24:27], s57 offen offset:1024 lds
    v_mfma_f32_32x32x16_bf16 v[64:79], a[24:27], v[172:175], v[64:79]
    ds_read_b128 v[164:167], v15 offset:2048
    ds_read_b64_tr_b16 a[40:41], v18 offset:20480
    ds_read_b64_tr_b16 a[42:43], v18 offset:21504
    s_mul_i32 s62, s62, 237568
    s_lshl_b32 s67, s18, 5
    s_add_u32 s67, s67, s62
    s_add_u32 s68, s18, s62
    s_add_u32 s68, s68, 114688
    s_mov_b32 s74, 0xbfb8aa3b
    s_mov_b32 s75, s74
    buffer_load_dwordx4 v8, s[24:27], s57 offen offset:2048 lds
    v_mfma_f32_32x32x16_bf16 v[80:95], a[28:31], v[172:175], v[80:95]
    ds_read_b64_tr_b16 a[44:45], v19 offset:20480
    ds_read_b64_tr_b16 a[46:47], v19 offset:21504
    s_mov_b32 s76, 0.5
    s_mov_b32 s77, 0.5
    v_add_u32 v4, 30720, v2
    v_add_u32 v5, 30720, v3
    v_add_u32 v176, 32768, v14
    v_add_u32 v177, 32768, v15
    v_add_u32 v178, 32768, v16
    buffer_load_dwordx4 v9, s[24:27], s57 offen offset:3072 lds
    s_waitcnt lgkmcnt(7)
    v_mfma_f32_32x32x16_bf16 v[64:79], a[32:35], v[160:163], v[64:79]
    ds_read_b128 v[168:171], v16 offset:2048
    ds_read_b64_tr_b16 a[48:49], v18 offset:24576
    ds_read_b64_tr_b16 a[50:51], v18 offset:25600
    v_add_u32 v179, 32768, v17
    s_add_u32 m0, s58, 49152
    s_xor_b32 s61, s61, 7
    s_lshl_b32 s56, s61, 7
    s_add_u32 s56, s56, s54
    buffer_load_dwordx4 v2, s[20:23], s56 offen offset:0 lds
    s_waitcnt lgkmcnt(8)
    v_mfma_f32_32x32x16_bf16 v[80:95], a[36:39], v[160:163], v[80:95]
    ds_read_b64_tr_b16 a[52:53], v19 offset:24576
    ds_read_b64_tr_b16 a[54:55], v19 offset:25600
    buffer_load_dwordx4 v3, s[20:23], s56 offen offset:1024 lds
    s_waitcnt lgkmcnt(7)
    v_mfma_f32_32x32x16_bf16 v[64:79], a[40:43], v[164:167], v[64:79]
    ds_read_b128 v[172:175], v17 offset:2048
    ds_read_b64_tr_b16 a[56:57], v18 offset:28672
    ds_read_b64_tr_b16 a[58:59], v18 offset:29696
    s_waitcnt lgkmcnt(8)
    v_mfma_f32_32x32x16_bf16 v[80:95], a[44:47], v[164:167], v[80:95]
    ds_read_b64_tr_b16 a[60:61], v19 offset:28672
    ds_read_b64_tr_b16 a[62:63], v19 offset:29696
    s_waitcnt lgkmcnt(7)
    v_mfma_f32_32x32x16_bf16 v[64:79], a[48:51], v[168:171], v[64:79]
    s_waitcnt vmcnt(8)
    s_waitcnt lgkmcnt(0)
    s_barrier
    ds_read_b128 v[160:163], v14 offset:16384
    ds_read_b64_tr_b16 a[64:65], v18 offset:32768
    ds_read_b64_tr_b16 a[66:67], v18 offset:33792
    s_add_u32 m0, s58, 16384
    s_mul_i32 s57, s61, 229376
    s_add_u32 s57, s57, s55
    buffer_load_dwordx4 v6, s[24:27], s57 offen offset:0 lds
    v_mfma_f32_32x32x16_bf16 v[80:95], a[52:55], v[168:171], v[80:95]
    ds_read_b64_tr_b16 a[68:69], v19 offset:32768
    ds_read_b64_tr_b16 a[70:71], v19 offset:33792
    buffer_load_dwordx4 v7, s[24:27], s57 offen offset:1024 lds
    v_mfma_f32_32x32x16_bf16 v[64:79], a[56:59], v[172:175], v[64:79]
    ds_read_b128 v[164:167], v15 offset:16384
    ds_read_b64_tr_b16 a[72:73], v18 offset:36864
    ds_read_b64_tr_b16 a[74:75], v18 offset:37888
    buffer_load_dwordx4 v8, s[24:27], s57 offen offset:2048 lds
    v_mfma_f32_32x32x16_bf16 v[80:95], a[60:63], v[172:175], v[80:95]
    ds_read_b64_tr_b16 a[76:77], v19 offset:36864
    ds_read_b64_tr_b16 a[78:79], v19 offset:37888
    buffer_load_dwordx4 v9, s[24:27], s57 offen offset:3072 lds
    s_waitcnt lgkmcnt(7)
    v_mfma_f32_32x32x16_bf16 v[64:79], a[64:67], v[160:163], v[64:79]
    ds_read_b128 v[168:171], v16 offset:16384
    ds_read_b64_tr_b16 a[80:81], v18 offset:40960
    ds_read_b64_tr_b16 a[82:83], v18 offset:41984
    s_add_u32 m0, s58, 51200
    s_xor_b32 s61, s61, 1
    s_lshl_b32 s56, s61, 7
    s_add_u32 s56, s56, s54
    buffer_load_dwordx4 v2, s[20:23], s56 offen offset:0 lds
    s_waitcnt lgkmcnt(8)
    v_mfma_f32_32x32x16_bf16 v[80:95], a[68:71], v[160:163], v[80:95]
    ds_read_b64_tr_b16 a[84:85], v19 offset:40960
    ds_read_b64_tr_b16 a[86:87], v19 offset:41984
    buffer_load_dwordx4 v3, s[20:23], s56 offen offset:1024 lds
    s_waitcnt lgkmcnt(7)
    v_mfma_f32_32x32x16_bf16 v[64:79], a[72:75], v[164:167], v[64:79]
    ds_read_b128 v[172:175], v17 offset:16384
    ds_read_b64_tr_b16 a[88:89], v18 offset:45056
    ds_read_b64_tr_b16 a[90:91], v18 offset:46080
    s_waitcnt lgkmcnt(8)
    v_mfma_f32_32x32x16_bf16 v[80:95], a[76:79], v[164:167], v[80:95]
    ds_read_b64_tr_b16 a[92:93], v19 offset:45056
    ds_read_b64_tr_b16 a[94:95], v19 offset:46080
    s_waitcnt lgkmcnt(7)
    v_mfma_f32_32x32x16_bf16 v[64:79], a[80:83], v[168:171], v[64:79]
    s_waitcnt vmcnt(8)
    s_waitcnt lgkmcnt(0)
    s_barrier
    ds_read_b128 v[160:163], v14 offset:18432
    ds_read_b64_tr_b16 a[96:97], v18 offset:0
    ds_read_b64_tr_b16 a[98:99], v18 offset:1024
    s_add_u32 m0, s58, 32768
    s_mul_i32 s57, s61, 229376
    s_add_u32 s57, s57, s55
    buffer_load_dwordx4 v6, s[24:27], s57 offen offset:0 lds
    v_mfma_f32_32x32x16_bf16 v[80:95], a[84:87], v[168:171], v[80:95]
    ds_read_b64_tr_b16 a[100:101], v19 offset:0
    ds_read_b64_tr_b16 a[102:103], v19 offset:1024
    buffer_load_dwordx4 v7, s[24:27], s57 offen offset:1024 lds
    v_mfma_f32_32x32x16_bf16 v[64:79], a[88:91], v[172:175], v[64:79]
    ds_read_b128 v[164:167], v15 offset:18432
    ds_read_b64_tr_b16 a[104:105], v18 offset:4096
    ds_read_b64_tr_b16 a[106:107], v18 offset:5120
    buffer_load_dwordx4 v8, s[24:27], s57 offen offset:2048 lds
    v_mfma_f32_32x32x16_bf16 v[80:95], a[92:95], v[172:175], v[80:95]
    ds_read_b64_tr_b16 a[108:109], v19 offset:4096
    ds_read_b64_tr_b16 a[110:111], v19 offset:5120
    buffer_load_dwordx4 v9, s[24:27], s57 offen offset:3072 lds
    s_waitcnt lgkmcnt(7)
    v_mfma_f32_32x32x16_bf16 v[64:79], a[96:99], v[160:163], v[64:79]
    ds_read_b128 v[168:171], v16 offset:18432
    ds_read_b64_tr_b16 a[112:113], v18 offset:8192
    ds_read_b64_tr_b16 a[114:115], v18 offset:9216
    s_add_u32 m0, s58, 65536
    s_xor_b32 s61, s61, 3
    s_lshl_b32 s56, s61, 7
    s_add_u32 s56, s56, s54
    buffer_load_dwordx4 v2, s[20:23], s56 offen offset:0 lds
    s_waitcnt lgkmcnt(8)
    v_mfma_f32_32x32x16_bf16 v[80:95], a[100:103], v[160:163], v[80:95]
    ds_read_b64_tr_b16 a[116:117], v19 offset:8192
    ds_read_b64_tr_b16 a[118:119], v19 offset:9216
    buffer_load_dwordx4 v3, s[20:23], s56 offen offset:1024 lds
    s_waitcnt lgkmcnt(7)
    v_mfma_f32_32x32x16_bf16 v[64:79], a[104:107], v[164:167], v[64:79]
    ds_read_b128 v[172:175], v17 offset:18432
    ds_read_b64_tr_b16 a[120:121], v18 offset:12288
    ds_read_b64_tr_b16 a[122:123], v18 offset:13312
    s_waitcnt lgkmcnt(8)
    v_mfma_f32_32x32x16_bf16 v[80:95], a[108:111], v[164:167], v[80:95]
    ds_read_b64_tr_b16 a[124:125], v19 offset:12288
    ds_read_b64_tr_b16 a[126:127], v19 offset:13312
    s_waitcnt lgkmcnt(7)
    v_mfma_f32_32x32x16_bf16 v[64:79], a[112:115], v[168:171], v[64:79]
    s_waitcnt vmcnt(8)
    s_waitcnt lgkmcnt(0)
    s_barrier
    ds_read_b128 v[160:163], v14 offset:0
    ds_read_b64_tr_b16 a[128:129], v18 offset:16384
    ds_read_b64_tr_b16 a[130:131], v18 offset:17408
    s_mov_b32 m0, s58
    s_mul_i32 s57, s61, 229376
    s_add_u32 s57, s57, s55
    buffer_load_dwordx4 v6, s[24:27], s57 offen offset:0 lds
    v_mfma_f32_32x32x16_bf16 v[80:95], a[116:119], v[168:171], v[80:95]
    ds_read_b64_tr_b16 a[132:133], v19 offset:16384
    ds_read_b64_tr_b16 a[134:135], v19 offset:17408
    buffer_load_dwordx4 v7, s[24:27], s57 offen offset:1024 lds
    v_mfma_f32_32x32x16_bf16 v[64:79], a[120:123], v[172:175], v[64:79]
    ds_read_b128 v[164:167], v15 offset:0
    ds_read_b64_tr_b16 a[136:137], v18 offset:20480
    ds_read_b64_tr_b16 a[138:139], v18 offset:21504
    buffer_load_dwordx4 v8, s[24:27], s57 offen offset:2048 lds
    v_mfma_f32_32x32x16_bf16 v[80:95], a[124:127], v[172:175], v[80:95]
    ds_read_b64_tr_b16 a[140:141], v19 offset:20480
    ds_read_b64_tr_b16 a[142:143], v19 offset:21504
    buffer_load_dwordx4 v9, s[24:27], s57 offen offset:3072 lds
    s_waitcnt lgkmcnt(7)
    v_mfma_f32_32x32x16_bf16 v[64:79], a[128:131], v[160:163], v[64:79]
    ds_read_b128 v[168:171], v16 offset:0
    ds_read_b64_tr_b16 a[144:145], v18 offset:24576
    ds_read_b64_tr_b16 a[146:147], v18 offset:25600
    s_add_u32 m0, s58, 67584
    s_xor_b32 s61, s61, 1
    s_lshl_b32 s56, s61, 7
    s_add_u32 s56, s56, s54
    buffer_load_dwordx4 v2, s[20:23], s56 offen offset:0 lds
    s_waitcnt lgkmcnt(8)
    v_mfma_f32_32x32x16_bf16 v[80:95], a[132:135], v[160:163], v[80:95]
    ds_read_b64_tr_b16 a[148:149], v19 offset:24576
    ds_read_b64_tr_b16 a[150:151], v19 offset:25600
    buffer_load_dwordx4 v3, s[20:23], s56 offen offset:1024 lds
    s_waitcnt lgkmcnt(7)
    v_mfma_f32_32x32x16_bf16 v[64:79], a[136:139], v[164:167], v[64:79]
    ds_read_b128 v[172:175], v17 offset:0
    ds_read_b64_tr_b16 a[152:153], v18 offset:28672
    ds_read_b64_tr_b16 a[154:155], v18 offset:29696
    s_waitcnt lgkmcnt(8)
    v_mfma_f32_32x32x16_bf16 v[80:95], a[140:143], v[164:167], v[80:95]
    ds_read_b64_tr_b16 a[156:157], v19 offset:28672
    ds_read_b64_tr_b16 a[158:159], v19 offset:29696
    s_waitcnt lgkmcnt(7)
    v_mfma_f32_32x32x16_bf16 v[64:79], a[144:147], v[168:171], v[64:79]
    s_waitcnt vmcnt(8)
    s_waitcnt lgkmcnt(0)
    s_barrier
    ds_read_b128 v[160:163], v14 offset:2048
    ds_read_b64_tr_b16 a[160:161], v18 offset:32768
    ds_read_b64_tr_b16 a[162:163], v18 offset:33792
    s_add_u32 m0, s58, 16384
    s_mul_i32 s57, s61, 229376
    s_add_u32 s57, s57, s55
    buffer_load_dwordx4 v6, s[24:27], s57 offen offset:0 lds
    v_mfma_f32_32x32x16_bf16 v[80:95], a[148:151], v[168:171], v[80:95]
    ds_read_b64_tr_b16 a[164:165], v19 offset:32768
    ds_read_b64_tr_b16 a[166:167], v19 offset:33792
    buffer_load_dwordx4 v7, s[24:27], s57 offen offset:1024 lds
    v_mfma_f32_32x32x16_bf16 v[64:79], a[152:155], v[172:175], v[64:79]
    ds_read_b128 v[164:167], v15 offset:2048
    ds_read_b64_tr_b16 a[168:169], v18 offset:36864
    ds_read_b64_tr_b16 a[170:171], v18 offset:37888
    buffer_load_dwordx4 v8, s[24:27], s57 offen offset:2048 lds
    v_mfma_f32_32x32x16_bf16 v[80:95], a[156:159], v[172:175], v[80:95]
    ds_read_b64_tr_b16 a[172:173], v19 offset:36864
    ds_read_b64_tr_b16 a[174:175], v19 offset:37888
    buffer_load_dwordx4 v9, s[24:27], s57 offen offset:3072 lds
    s_waitcnt lgkmcnt(7)
    v_mfma_f32_32x32x16_bf16 v[64:79], a[160:163], v[160:163], v[64:79]
    ds_read_b128 v[168:171], v16 offset:2048
    ds_read_b64_tr_b16 a[176:177], v18 offset:40960
    ds_read_b64_tr_b16 a[178:179], v18 offset:41984
    s_add_u32 m0, s58, 79872
    s_xor_b32 s61, s61, 7
    s_lshl_b32 s56, s61, 7
    s_add_u32 s56, s56, s54
    buffer_load_dwordx4 v4, s[20:23], s56 offen offset:2048 lds
    s_waitcnt lgkmcnt(8)
    v_mfma_f32_32x32x16_bf16 v[80:95], a[164:167], v[160:163], v[80:95]
    ds_read_b64_tr_b16 a[180:181], v19 offset:40960
    ds_read_b64_tr_b16 a[182:183], v19 offset:41984
    buffer_load_dwordx4 v5, s[20:23], s56 offen offset:3072 lds
    s_waitcnt lgkmcnt(7)
    v_mfma_f32_32x32x16_bf16 v[64:79], a[168:171], v[164:167], v[64:79]
    ds_read_b128 v[172:175], v17 offset:2048
    ds_read_b64_tr_b16 a[184:185], v18 offset:45056
    ds_read_b64_tr_b16 a[186:187], v18 offset:46080
    s_add_u32 m0, s58, 81920
    s_xor_b32 s61, s61, 1
    s_lshl_b32 s56, s61, 7
    s_add_u32 s56, s56, s54
    buffer_load_dwordx4 v4, s[20:23], s56 offen offset:2048 lds
    s_waitcnt lgkmcnt(8)
    v_mfma_f32_32x32x16_bf16 v[80:95], a[172:175], v[164:167], v[80:95]
    ds_read_b64_tr_b16 a[188:189], v19 offset:45056
    ds_read_b64_tr_b16 a[190:191], v19 offset:46080
    buffer_load_dwordx4 v5, s[20:23], s56 offen offset:3072 lds
    s_waitcnt lgkmcnt(7)
    v_mfma_f32_32x32x16_bf16 v[64:79], a[176:179], v[168:171], v[64:79]
    s_waitcnt vmcnt(10)
    s_waitcnt lgkmcnt(0)
    s_barrier
    ds_read_b128 v[160:163], v14 offset:16384
    ds_read_b64_tr_b16 a[192:193], v18 offset:0
    ds_read_b64_tr_b16 a[194:195], v18 offset:1024
    s_add_u32 m0, s58, 96256
    s_xor_b32 s61, s61, 3
    s_lshl_b32 s56, s61, 7
    s_add_u32 s56, s56, s54
    buffer_load_dwordx4 v4, s[20:23], s56 offen offset:2048 lds
    v_mfma_f32_32x32x16_bf16 v[80:95], a[180:183], v[168:171], v[80:95]
    ds_read_b64_tr_b16 a[196:197], v19 offset:0
    ds_read_b64_tr_b16 a[198:199], v19 offset:1024
    buffer_load_dwordx4 v5, s[20:23], s56 offen offset:3072 lds
    v_mfma_f32_32x32x16_bf16 v[64:79], a[184:187], v[172:175], v[64:79]
    ds_read_b128 v[164:167], v15 offset:16384
    ds_read_b64_tr_b16 a[200:201], v18 offset:4096
    ds_read_b64_tr_b16 a[202:203], v18 offset:5120
    s_add_u32 m0, s58, 98304
    s_xor_b32 s61, s61, 1
    s_lshl_b32 s56, s61, 7
    s_add_u32 s56, s56, s54
    buffer_load_dwordx4 v4, s[20:23], s56 offen offset:2048 lds
    v_mfma_f32_32x32x16_bf16 v[80:95], a[188:191], v[172:175], v[80:95]
    ds_read_b64_tr_b16 a[204:205], v19 offset:4096
    ds_read_b64_tr_b16 a[206:207], v19 offset:5120
    buffer_load_dwordx4 v5, s[20:23], s56 offen offset:3072 lds
    s_waitcnt lgkmcnt(7)
    v_mfma_f32_32x32x16_bf16 v[64:79], a[192:195], v[160:163], v[64:79]
    ds_read_b128 v[168:171], v16 offset:16384
    ds_read_b64_tr_b16 a[208:209], v18 offset:8192
    ds_read_b64_tr_b16 a[210:211], v18 offset:9216
    s_add_u32 m0, s58, 112640
    s_xor_b32 s61, s61, 7
    s_lshl_b32 s56, s61, 7
    s_add_u32 s56, s56, s54
    buffer_load_dwordx4 v4, s[20:23], s56 offen offset:2048 lds
    s_waitcnt lgkmcnt(8)
    v_mfma_f32_32x32x16_bf16 v[80:95], a[196:199], v[160:163], v[80:95]
    ds_read_b64_tr_b16 a[212:213], v19 offset:8192
    ds_read_b64_tr_b16 a[214:215], v19 offset:9216
    buffer_load_dwordx4 v5, s[20:23], s56 offen offset:3072 lds
    s_waitcnt lgkmcnt(7)
    v_mfma_f32_32x32x16_bf16 v[64:79], a[200:203], v[164:167], v[64:79]
    ds_read_b128 v[172:175], v17 offset:16384
    ds_read_b64_tr_b16 a[216:217], v18 offset:12288
    ds_read_b64_tr_b16 a[218:219], v18 offset:13312
    s_add_u32 m0, s58, 114688
    s_xor_b32 s61, s61, 1
    s_lshl_b32 s56, s61, 7
    s_add_u32 s56, s56, s54
    buffer_load_dwordx4 v4, s[20:23], s56 offen offset:2048 lds
    s_waitcnt lgkmcnt(8)
    v_mfma_f32_32x32x16_bf16 v[80:95], a[204:207], v[164:167], v[80:95]
    ds_read_b64_tr_b16 a[220:221], v19 offset:12288
    ds_read_b64_tr_b16 a[222:223], v19 offset:13312
    buffer_load_dwordx4 v5, s[20:23], s56 offen offset:3072 lds
    s_waitcnt lgkmcnt(7)
    v_mfma_f32_32x32x16_bf16 v[64:79], a[208:211], v[168:171], v[64:79]
    s_waitcnt vmcnt(12)
    s_waitcnt lgkmcnt(0)
    s_barrier
    ds_read_b128 v[160:163], v14 offset:18432
    ds_read_b64_tr_b16 a[224:225], v18 offset:16384
    ds_read_b64_tr_b16 a[226:227], v18 offset:17408
    s_add_u32 m0, s58, 129024
    s_xor_b32 s61, s61, 3
    s_lshl_b32 s56, s61, 7
    s_add_u32 s56, s56, s54
    buffer_load_dwordx4 v4, s[20:23], s56 offen offset:2048 lds
    v_mfma_f32_32x32x16_bf16 v[80:95], a[212:215], v[168:171], v[80:95]
    ds_read_b64_tr_b16 a[228:229], v19 offset:16384
    ds_read_b64_tr_b16 a[230:231], v19 offset:17408
    buffer_load_dwordx4 v5, s[20:23], s56 offen offset:3072 lds
    v_mfma_f32_32x32x16_bf16 v[64:79], a[216:219], v[172:175], v[64:79]
    ds_read_b128 v[164:167], v15 offset:18432
    ds_read_b64_tr_b16 a[232:233], v18 offset:20480
    ds_read_b64_tr_b16 a[234:235], v18 offset:21504
    s_add_u32 m0, s58, 131072
    s_xor_b32 s61, s61, 1
    s_lshl_b32 s56, s61, 7
    s_add_u32 s56, s56, s54
    buffer_load_dwordx4 v4, s[20:23], s56 offen offset:2048 lds
    v_mfma_f32_32x32x16_bf16 v[80:95], a[220:223], v[172:175], v[80:95]
    ds_read_b64_tr_b16 a[236:237], v19 offset:20480
    ds_read_b64_tr_b16 a[238:239], v19 offset:21504
    buffer_load_dwordx4 v5, s[20:23], s56 offen offset:3072 lds
    s_waitcnt lgkmcnt(7)
    v_mfma_f32_32x32x16_bf16 v[64:79], a[224:227], v[160:163], v[64:79]
    ds_read_b128 v[168:171], v16 offset:18432
    ds_read_b64_tr_b16 a[240:241], v18 offset:24576
    ds_read_b64_tr_b16 a[242:243], v18 offset:25600
    s_add_u32 m0, s58, 147456
    s_add_u32 s56, s79, 0
    s_waitcnt lgkmcnt(8)
    v_mfma_f32_32x32x16_bf16 v[80:95], a[228:231], v[160:163], v[80:95]
    ds_read_b64_tr_b16 a[244:245], v19 offset:24576
    ds_read_b64_tr_b16 a[246:247], v19 offset:25600
    buffer_load_dwordx4 v10, s[8:11], s56 offen offset:0 lds
    s_waitcnt lgkmcnt(7)
    v_mfma_f32_32x32x16_bf16 v[64:79], a[232:235], v[164:167], v[64:79]
    ds_read_b128 v[172:175], v17 offset:18432
    ds_read_b64_tr_b16 a[248:249], v18 offset:28672
    ds_read_b64_tr_b16 a[250:251], v18 offset:29696
    buffer_load_dwordx4 v11, s[8:11], s56 offen offset:1024 lds
    s_waitcnt lgkmcnt(8)
    v_mfma_f32_32x32x16_bf16 v[80:95], a[236:239], v[164:167], v[80:95]
    ds_read_b64_tr_b16 a[252:253], v19 offset:28672
    ds_read_b64_tr_b16 a[254:255], v19 offset:29696
    s_waitcnt lgkmcnt(7)
    v_mfma_f32_32x32x16_bf16 v[64:79], a[240:243], v[168:171], v[64:79]
    s_waitcnt vmcnt(14)
    s_waitcnt lgkmcnt(0)
    s_barrier
    ds_read_b128 v[160:163], v176 offset:0
    buffer_load_dwordx4 v12, s[8:11], s56 offen offset:2048 lds
    v_mfma_f32_32x32x16_bf16 v[80:95], a[244:247], v[168:171], v[80:95]
    buffer_load_dwordx4 v13, s[8:11], s56 offen offset:3072 lds
    v_mfma_f32_32x32x16_bf16 v[64:79], a[248:251], v[172:175], v[64:79]
    ds_read_b128 v[164:167], v177 offset:0
    s_add_u32 m0, s58, 32768
    s_add_u32 s56, s79, 32768
    v_mfma_f32_32x32x16_bf16 v[80:95], a[252:255], v[172:175], v[80:95]
    buffer_load_dwordx4 v10, s[8:11], s56 offen offset:0 lds
    s_waitcnt lgkmcnt(1)
    v_mfma_f32_32x32x16_bf16 v[96:111], a[0:3], v[160:163], v[96:111]
    ds_read_b128 v[168:171], v178 offset:0
    buffer_load_dwordx4 v11, s[8:11], s56 offen offset:1024 lds
    v_mfma_f32_32x32x16_bf16 v[112:127], a[4:7], v[160:163], v[112:127]
    s_waitcnt lgkmcnt(1)
    v_mfma_f32_32x32x16_bf16 v[96:111], a[8:11], v[164:167], v[96:111]
    ds_read_b128 v[172:175], v179 offset:0
    buffer_load_dwordx4 v12, s[8:11], s56 offen offset:2048 lds
    v_mfma_f32_32x32x16_bf16 v[112:127], a[12:15], v[164:167], v[112:127]
    buffer_load_dwordx4 v13, s[8:11], s56 offen offset:3072 lds
    s_waitcnt lgkmcnt(1)
    v_mfma_f32_32x32x16_bf16 v[96:111], a[16:19], v[168:171], v[96:111]
    ds_read_b128 v[160:163], v176 offset:2048
    v_mul_f32 v192, s74, v64
    v_exp_f32 v192, v192
    v_mul_f32 v193, s74, v65
    v_exp_f32 v193, v193
    s_add_u32 m0, s58, 49152
    s_add_u32 s56, s79, 65536
    v_mfma_f32_32x32x16_bf16 v[112:127], a[20:23], v[168:171], v[112:127]
    v_add_f32 v200, 0.5, v192
    v_mul_f32 v194, s74, v66
    v_exp_f32 v194, v194
    v_fma_f32 v208, v192, v192, v200
    v_add_f32 v201, 0.5, v193
    v_mul_f32 v195, s74, v67
    buffer_load_dwordx4 v10, s[8:11], s56 offen offset:0 lds
    s_waitcnt lgkmcnt(1)
    v_mfma_f32_32x32x16_bf16 v[96:111], a[24:27], v[172:175], v[96:111]
    ds_read_b128 v[164:167], v177 offset:2048
    v_exp_f32 v195, v195
    v_fma_f32 v209, v193, v193, v201
    v_rcp_f32 v208, v208
    v_add_f32 v202, 0.5, v194
    buffer_load_dwordx4 v11, s[8:11], s56 offen offset:1024 lds
    v_mfma_f32_32x32x16_bf16 v[112:127], a[28:31], v[172:175], v[112:127]
    v_mul_f32 v196, s74, v68
    v_exp_f32 v196, v196
    v_mul_f32 v200, v200, v208 clamp
    v_fma_f32 v210, v194, v194, v202
    v_rcp_f32 v209, v209
    s_waitcnt lgkmcnt(1)
    v_mfma_f32_32x32x16_bf16 v[96:111], a[32:35], v[160:163], v[96:111]
    ds_read_b128 v[168:171], v178 offset:2048
    v_add_f32 v203, 0.5, v195
    v_mul_f32 v197, s74, v69
    v_exp_f32 v197, v197
    v_mul_f32 v200, v200, v64
    buffer_load_dwordx4 v12, s[8:11], s56 offen offset:2048 lds
    v_mfma_f32_32x32x16_bf16 v[112:127], a[36:39], v[160:163], v[112:127]
    v_mul_f32 v201, v201, v209 clamp
    v_fma_f32 v211, v195, v195, v203
    v_rcp_f32 v210, v210
    v_add_f32 v204, 0.5, v196
    v_mul_f32 v198, s74, v70
    buffer_load_dwordx4 v13, s[8:11], s56 offen offset:3072 lds
    s_waitcnt lgkmcnt(1)
    v_mfma_f32_32x32x16_bf16 v[96:111], a[40:43], v[164:167], v[96:111]
    ds_read_b128 v[172:175], v179 offset:2048
    v_exp_f32 v198, v198
    v_mul_f32 v201, v201, v65
    v_mul_f32 v202, v202, v210 clamp
    v_fma_f32 v212, v196, v196, v204
    v_rcp_f32 v211, v211
    s_mov_b32 m0, s58
    s_add_u32 s56, s79, 98304
    v_mfma_f32_32x32x16_bf16 v[112:127], a[44:47], v[164:167], v[112:127]
    v_add_f32 v205, 0.5, v197
    v_mul_f32 v199, s74, v71
    v_cvt_pk_bf16_f32 v216, v200, v201
    v_exp_f32 v199, v199
    v_mul_f32 v202, v202, v66
    buffer_load_dwordx4 v10, s[8:11], s56 offen offset:0 lds
    s_waitcnt lgkmcnt(1)
    v_mfma_f32_32x32x16_bf16 v[96:111], a[48:51], v[168:171], v[96:111]
    s_waitcnt vmcnt(21)
    s_waitcnt lgkmcnt(0)
    s_barrier
    ds_read_b128 v[160:163], v176 offset:16384
    v_mul_f32 v203, v203, v211 clamp
    v_fma_f32 v213, v197, v197, v205
    v_rcp_f32 v212, v212
    v_add_f32 v206, 0.5, v198
    v_mul_f32 v192, s74, v72
    buffer_load_dwordx4 v11, s[8:11], s56 offen offset:1024 lds
    v_mfma_f32_32x32x16_bf16 v[112:127], a[52:55], v[168:171], v[112:127]
    v_exp_f32 v192, v192
    v_mul_f32 v203, v203, v67
    v_mul_f32 v204, v204, v212 clamp
    v_fma_f32 v214, v198, v198, v206
    v_rcp_f32 v213, v213
    v_mfma_f32_32x32x16_bf16 v[96:111], a[56:59], v[172:175], v[96:111]
    ds_read_b128 v[164:167], v177 offset:16384
    v_add_f32 v207, 0.5, v199
    v_mul_f32 v193, s74, v73
    v_cvt_pk_bf16_f32 v217, v202, v203
    v_exp_f32 v193, v193
    buffer_load_dwordx4 v12, s[8:11], s56 offen offset:2048 lds
    v_mfma_f32_32x32x16_bf16 v[112:127], a[60:63], v[172:175], v[112:127]
    v_mul_f32 v204, v204, v68
    v_mul_f32 v205, v205, v213 clamp
    v_fma_f32 v215, v199, v199, v207
    v_rcp_f32 v214, v214
    v_add_f32 v200, 0.5, v192
    buffer_load_dwordx4 v13, s[8:11], s56 offen offset:3072 lds
    s_waitcnt lgkmcnt(1)
    v_mfma_f32_32x32x16_bf16 v[96:111], a[64:67], v[160:163], v[96:111]
    ds_read_b128 v[168:171], v178 offset:16384
    v_mul_f32 v194, s74, v74
    v_exp_f32 v194, v194
    v_mul_f32 v205, v205, v69
    v_mul_f32 v206, v206, v214 clamp
    v_fma_f32 v208, v192, v192, v200
    s_add_u32 m0, s58, 16384
    s_add_u32 s56, s79, 131072
    v_mfma_f32_32x32x16_bf16 v[112:127], a[68:71], v[160:163], v[112:127]
    v_rcp_f32 v215, v215
    v_add_f32 v201, 0.5, v193
    v_mul_f32 v195, s74, v75
    v_cvt_pk_bf16_f32 v218, v204, v205
    v_exp_f32 v195, v195
    buffer_load_dwordx4 v10, s[8:11], s56 offen offset:0 lds
    s_waitcnt lgkmcnt(1)
    v_mfma_f32_32x32x16_bf16 v[96:111], a[72:75], v[164:167], v[96:111]
    ds_read_b128 v[172:175], v179 offset:16384
    v_mul_f32 v206, v206, v70
    v_mul_f32 v207, v207, v215 clamp
    v_fma_f32 v209, v193, v193, v201
    v_rcp_f32 v208, v208
    buffer_load_dwordx4 v11, s[8:11], s56 offen offset:1024 lds
    v_mfma_f32_32x32x16_bf16 v[112:127], a[76:79], v[164:167], v[112:127]
    v_add_f32 v202, 0.5, v194
    v_mul_f32 v196, s74, v76
    v_exp_f32 v196, v196
    v_mul_f32 v207, v207, v71
    v_mul_f32 v200, v200, v208 clamp
    s_waitcnt lgkmcnt(1)
    v_mfma_f32_32x32x16_bf16 v[96:111], a[80:83], v[168:171], v[96:111]
    ds_read_b128 v[160:163], v176 offset:18432
    v_fma_f32 v210, v194, v194, v202
    v_rcp_f32 v209, v209
    v_add_f32 v203, 0.5, v195
    v_mul_f32 v197, s74, v77
    v_cvt_pk_bf16_f32 v219, v206, v207
    buffer_store_dwordx4 v[216:219], v24, s[32:35], s67 offen offset:0 sc1
    buffer_load_dwordx4 v12, s[8:11], s56 offen offset:2048 lds
    v_mfma_f32_32x32x16_bf16 v[112:127], a[84:87], v[168:171], v[112:127]
    v_exp_f32 v197, v197
    v_mul_f32 v200, v200, v72
    v_mul_f32 v201, v201, v209 clamp
    v_fma_f32 v211, v195, v195, v203
    v_rcp_f32 v210, v210
    buffer_load_dwordx4 v13, s[8:11], s56 offen offset:3072 lds
    s_waitcnt lgkmcnt(1)
    v_mfma_f32_32x32x16_bf16 v[96:111], a[88:91], v[172:175], v[96:111]
    ds_read_b128 v[164:167], v177 offset:18432
    v_add_f32 v204, 0.5, v196
    v_mul_f32 v198, s74, v78
    v_exp_f32 v198, v198
    v_mul_f32 v201, v201, v73
    v_mul_f32 v202, v202, v210 clamp
    s_add_u32 m0, s58, 65536
    s_add_u32 s56, s79, 163840
    v_mfma_f32_32x32x16_bf16 v[112:127], a[92:95], v[172:175], v[112:127]
    v_fma_f32 v212, v196, v196, v204
    v_rcp_f32 v211, v211
    v_add_f32 v205, 0.5, v197
    v_mul_f32 v199, s74, v79
    v_cvt_pk_bf16_f32 v220, v200, v201
    buffer_load_dwordx4 v10, s[8:11], s56 offen offset:0 lds
    s_waitcnt lgkmcnt(1)
    v_mfma_f32_32x32x16_bf16 v[96:111], a[96:99], v[160:163], v[96:111]
    ds_read_b128 v[168:171], v178 offset:18432
    v_exp_f32 v199, v199
    v_mul_f32 v202, v202, v74
    v_mul_f32 v203, v203, v211 clamp
    v_fma_f32 v213, v197, v197, v205
    buffer_load_dwordx4 v11, s[8:11], s56 offen offset:1024 lds
    v_mfma_f32_32x32x16_bf16 v[112:127], a[100:103], v[160:163], v[112:127]
    v_rcp_f32 v212, v212
    v_add_f32 v206, 0.5, v198
    v_mul_f32 v192, s74, v80
    v_exp_f32 v192, v192
    v_mul_f32 v203, v203, v75
    s_waitcnt lgkmcnt(1)
    v_mfma_f32_32x32x16_bf16 v[96:111], a[104:107], v[164:167], v[96:111]
    ds_read_b128 v[172:175], v179 offset:18432
    v_mul_f32 v204, v204, v212 clamp
    v_fma_f32 v214, v198, v198, v206
    v_rcp_f32 v213, v213
    v_add_f32 v207, 0.5, v199
    v_mul_f32 v193, s74, v81
    buffer_load_dwordx4 v12, s[8:11], s56 offen offset:2048 lds
    v_mfma_f32_32x32x16_bf16 v[112:127], a[108:111], v[164:167], v[112:127]
    v_cvt_pk_bf16_f32 v221, v202, v203
    v_exp_f32 v193, v193
    v_mul_f32 v204, v204, v76
    v_mul_f32 v205, v205, v213 clamp
    v_fma_f32 v215, v199, v199, v207
    buffer_load_dwordx4 v13, s[8:11], s56 offen offset:3072 lds
    s_waitcnt lgkmcnt(1)
    v_mfma_f32_32x32x16_bf16 v[96:111], a[112:115], v[168:171], v[96:111]
    s_waitcnt vmcnt(29)
    s_waitcnt lgkmcnt(0)
    s_barrier
    ds_read_b128 v[160:163], v176 offset:32768
    v_rcp_f32 v214, v214
    v_add_f32 v200, 0.5, v192
    v_mul_f32 v194, s74, v82
    v_exp_f32 v194, v194
    s_add_u32 m0, s58, 81920
    s_add_u32 s56, s79, 196608
    v_mfma_f32_32x32x16_bf16 v[112:127], a[116:119], v[168:171], v[112:127]
    v_mul_f32 v205, v205, v77
    v_mul_f32 v206, v206, v214 clamp
    v_fma_f32 v208, v192, v192, v200
    v_rcp_f32 v215, v215
    v_add_f32 v201, 0.5, v193
    buffer_load_dwordx4 v10, s[8:11], s56 offen offset:0 lds
    v_mfma_f32_32x32x16_bf16 v[96:111], a[120:123], v[172:175], v[96:111]
    ds_read_b128 v[164:167], v177 offset:32768
    v_mul_f32 v195, s74, v83
    v_cvt_pk_bf16_f32 v222, v204, v205
    v_exp_f32 v195, v195
    v_mul_f32 v206, v206, v78
    v_mul_f32 v207, v207, v215 clamp
    buffer_load_dwordx4 v11, s[8:11], s56 offen offset:1024 lds
    v_mfma_f32_32x32x16_bf16 v[112:127], a[124:127], v[172:175], v[112:127]
    v_fma_f32 v209, v193, v193, v201
    v_rcp_f32 v208, v208
    v_add_f32 v202, 0.5, v194
    v_mul_f32 v196, s74, v84
    v_exp_f32 v196, v196
    s_waitcnt lgkmcnt(1)
    v_mfma_f32_32x32x16_bf16 v[96:111], a[128:131], v[160:163], v[96:111]
    ds_read_b128 v[168:171], v178 offset:32768
    v_mul_f32 v207, v207, v79
    v_mul_f32 v200, v200, v208 clamp
    v_fma_f32 v210, v194, v194, v202
    v_rcp_f32 v209, v209
    buffer_load_dwordx4 v12, s[8:11], s56 offen offset:2048 lds
    v_mfma_f32_32x32x16_bf16 v[112:127], a[132:135], v[160:163], v[112:127]
    v_add_f32 v203, 0.5, v195
    v_mul_f32 v197, s74, v85
    v_cvt_pk_bf16_f32 v223, v206, v207
    buffer_store_dwordx4 v[220:223], v24, s[32:35], s67 offen offset:1024 sc1
    v_exp_f32 v197, v197
    v_mul_f32 v200, v200, v80
    buffer_load_dwordx4 v13, s[8:11], s56 offen offset:3072 lds
    s_waitcnt lgkmcnt(1)
    v_mfma_f32_32x32x16_bf16 v[96:111], a[136:139], v[164:167], v[96:111]
    ds_read_b128 v[172:175], v179 offset:32768
    v_mul_f32 v201, v201, v209 clamp
    v_fma_f32 v211, v195, v195, v203
    v_rcp_f32 v210, v210
    v_add_f32 v204, 0.5, v196
    v_mul_f32 v198, s74, v86
    s_add_u32 m0, s58, 98304
    s_add_u32 s56, s79, 229376
    v_mfma_f32_32x32x16_bf16 v[112:127], a[140:143], v[164:167], v[112:127]
    v_exp_f32 v198, v198
    v_mul_f32 v201, v201, v81
    v_mul_f32 v202, v202, v210 clamp
    v_fma_f32 v212, v196, v196, v204
    v_rcp_f32 v211, v211
    buffer_load_dwordx4 v10, s[8:11], s56 offen offset:0 lds
    s_waitcnt lgkmcnt(1)
    v_mfma_f32_32x32x16_bf16 v[96:111], a[144:147], v[168:171], v[96:111]
    ds_read_b128 v[160:163], v176 offset:34816
    v_add_f32 v205, 0.5, v197
    v_mul_f32 v199, s74, v87
    v_cvt_pk_bf16_f32 v224, v200, v201
    v_exp_f32 v199, v199
    v_mul_f32 v202, v202, v82
    buffer_load_dwordx4 v11, s[8:11], s56 offen offset:1024 lds
    v_mfma_f32_32x32x16_bf16 v[112:127], a[148:151], v[168:171], v[112:127]
    v_mul_f32 v203, v203, v211 clamp
    v_fma_f32 v213, v197, v197, v205
    v_rcp_f32 v212, v212
    v_add_f32 v206, 0.5, v198
    v_mul_f32 v192, s74, v88
    s_waitcnt lgkmcnt(1)
    v_mfma_f32_32x32x16_bf16 v[96:111], a[152:155], v[172:175], v[96:111]
    ds_read_b128 v[164:167], v177 offset:34816
    v_exp_f32 v192, v192
    v_mul_f32 v203, v203, v83
    v_mul_f32 v204, v204, v212 clamp
    v_fma_f32 v214, v198, v198, v206
    v_rcp_f32 v213, v213
    buffer_load_dwordx4 v12, s[8:11], s56 offen offset:2048 lds
    v_mfma_f32_32x32x16_bf16 v[112:127], a[156:159], v[172:175], v[112:127]
    v_add_f32 v207, 0.5, v199
    v_mul_f32 v193, s74, v89
    v_cvt_pk_bf16_f32 v225, v202, v203
    v_exp_f32 v193, v193
    buffer_load_dwordx4 v13, s[8:11], s56 offen offset:3072 lds
    s_waitcnt lgkmcnt(1)
    v_mfma_f32_32x32x16_bf16 v[96:111], a[160:163], v[160:163], v[96:111]
    ds_read_b128 v[168:171], v178 offset:34816
    v_mul_f32 v204, v204, v84
    v_mul_f32 v205, v205, v213 clamp
    v_fma_f32 v215, v199, v199, v207
    v_rcp_f32 v214, v214
    v_add_f32 v200, 0.5, v192
    v_mfma_f32_32x32x16_bf16 v[112:127], a[164:167], v[160:163], v[112:127]
    v_mul_f32 v194, s74, v90
    v_exp_f32 v194, v194
    v_mul_f32 v205, v205, v85
    v_mul_f32 v206, v206, v214 clamp
    v_fma_f32 v208, v192, v192, v200
    s_waitcnt lgkmcnt(1)
    v_mfma_f32_32x32x16_bf16 v[96:111], a[168:171], v[164:167], v[96:111]
    ds_read_b128 v[172:175], v179 offset:34816
    v_rcp_f32 v215, v215
    v_add_f32 v201, 0.5, v193
    v_mul_f32 v195, s74, v91
    v_cvt_pk_bf16_f32 v226, v204, v205
    v_exp_f32 v195, v195
    v_mfma_f32_32x32x16_bf16 v[112:127], a[172:175], v[164:167], v[112:127]
    v_mul_f32 v206, v206, v86
    v_mul_f32 v207, v207, v215 clamp
    v_fma_f32 v209, v193, v193, v201
    v_rcp_f32 v208, v208
    s_waitcnt lgkmcnt(1)
    v_mfma_f32_32x32x16_bf16 v[96:111], a[176:179], v[168:171], v[96:111]
    s_waitcnt vmcnt(34)
    s_waitcnt lgkmcnt(0)
    s_barrier
    ds_read_b128 v[160:163], v176 offset:49152
    v_add_f32 v202, 0.5, v194
    v_mul_f32 v196, s74, v92
    v_exp_f32 v196, v196
    v_mul_f32 v207, v207, v87
    v_mul_f32 v200, v200, v208 clamp
    s_add_u32 m0, s58, 114688
    s_add_u32 s56, s79, 262144
    buffer_load_dwordx4 v10, s[8:11], s56 offen offset:0 lds
    v_mfma_f32_32x32x16_bf16 v[112:127], a[180:183], v[168:171], v[112:127]
    v_fma_f32 v210, v194, v194, v202
    v_rcp_f32 v209, v209
    v_add_f32 v203, 0.5, v195
    v_mul_f32 v197, s74, v93
    v_cvt_pk_bf16_f32 v227, v206, v207
    buffer_store_dwordx4 v[224:227], v24, s[32:35], s67 offen offset:2048 sc1
    buffer_load_dwordx4 v11, s[8:11], s56 offen offset:1024 lds
    v_mfma_f32_32x32x16_bf16 v[96:111], a[184:187], v[172:175], v[96:111]
    ds_read_b128 v[164:167], v177 offset:49152
    v_exp_f32 v197, v197
    v_mul_f32 v200, v200, v88
    v_mul_f32 v201, v201, v209 clamp
    v_fma_f32 v211, v195, v195, v203
    v_rcp_f32 v210, v210
    v_mfma_f32_32x32x16_bf16 v[112:127], a[188:191], v[172:175], v[112:127]
    v_add_f32 v204, 0.5, v196
    v_mul_f32 v198, s74, v94
    v_exp_f32 v198, v198
    v_mul_f32 v201, v201, v89
    v_mul_f32 v202, v202, v210 clamp
    buffer_load_dwordx4 v12, s[8:11], s56 offen offset:2048 lds
    s_waitcnt lgkmcnt(1)
    v_mfma_f32_32x32x16_bf16 v[96:111], a[192:195], v[160:163], v[96:111]
    ds_read_b128 v[168:171], v178 offset:49152
    v_fma_f32 v212, v196, v196, v204
    v_rcp_f32 v211, v211
    v_add_f32 v205, 0.5, v197
    v_mul_f32 v199, s74, v95
    v_cvt_pk_bf16_f32 v228, v200, v201
    buffer_load_dwordx4 v13, s[8:11], s56 offen offset:3072 lds
    v_mfma_f32_32x32x16_bf16 v[112:127], a[196:199], v[160:163], v[112:127]
    v_exp_f32 v199, v199
    v_mul_f32 v202, v202, v90
    v_mul_f32 v203, v203, v211 clamp
    v_fma_f32 v213, v197, v197, v205
    s_waitcnt lgkmcnt(1)
    v_mfma_f32_32x32x16_bf16 v[96:111], a[200:203], v[164:167], v[96:111]
    ds_read_b128 v[172:175], v179 offset:49152
    v_rcp_f32 v212, v212
    v_add_f32 v206, 0.5, v198
    v_mul_f32 v203, v203, v91
    v_mul_f32 v204, v204, v212 clamp
    v_fma_f32 v214, v198, v198, v206
    v_mfma_f32_32x32x16_bf16 v[112:127], a[204:207], v[164:167], v[112:127]
    v_rcp_f32 v213, v213
    v_add_f32 v207, 0.5, v199
    v_cvt_pk_bf16_f32 v229, v202, v203
    v_mul_f32 v204, v204, v92
    v_mul_f32 v205, v205, v213 clamp
    s_waitcnt lgkmcnt(1)
    v_mfma_f32_32x32x16_bf16 v[96:111], a[208:211], v[168:171], v[96:111]
    ds_read_b128 v[160:163], v176 offset:51200
    v_fma_f32 v215, v199, v199, v207
    v_rcp_f32 v214, v214
    v_mul_f32 v205, v205, v93
    v_mul_f32 v206, v206, v214 clamp
    v_rcp_f32 v215, v215
    v_mfma_f32_32x32x16_bf16 v[112:127], a[212:215], v[168:171], v[112:127]
    v_cvt_pk_bf16_f32 v230, v204, v205
    v_mul_f32 v206, v206, v94
    v_mul_f32 v207, v207, v215 clamp
    v_mul_f32 v207, v207, v95
    v_cvt_pk_bf16_f32 v231, v206, v207
    buffer_store_dwordx4 v[228:231], v24, s[32:35], s67 offen offset:3072 sc1
    s_waitcnt lgkmcnt(1)
    v_mfma_f32_32x32x16_bf16 v[96:111], a[216:219], v[172:175], v[96:111]
    ds_read_b128 v[164:167], v177 offset:51200
    v_mfma_f32_32x32x16_bf16 v[112:127], a[220:223], v[172:175], v[112:127]
    s_waitcnt lgkmcnt(1)
    v_mfma_f32_32x32x16_bf16 v[96:111], a[224:227], v[160:163], v[96:111]
    ds_read_b128 v[168:171], v178 offset:51200
    v_mfma_f32_32x32x16_bf16 v[112:127], a[228:231], v[160:163], v[112:127]
    s_waitcnt lgkmcnt(1)
    v_mfma_f32_32x32x16_bf16 v[96:111], a[232:235], v[164:167], v[96:111]
    ds_read_b128 v[172:175], v179 offset:51200
    v_mfma_f32_32x32x16_bf16 v[112:127], a[236:239], v[164:167], v[112:127]
    s_waitcnt lgkmcnt(1)
    v_mfma_f32_32x32x16_bf16 v[96:111], a[240:243], v[168:171], v[96:111]
    s_waitcnt lgkmcnt(0)
    s_barrier
    s_add_u32 m0, s58, 131072
    s_add_u32 s56, s79, 294912
    buffer_load_dwordx4 v10, s[8:11], s56 offen offset:0 lds
    v_mfma_f32_32x32x16_bf16 v[112:127], a[244:247], v[168:171], v[112:127]
    v_mfma_f32_32x32x16_bf16 v[96:111], a[248:251], v[172:175], v[96:111]
    buffer_load_dwordx4 v11, s[8:11], s56 offen offset:1024 lds
    v_mfma_f32_32x32x16_bf16 v[112:127], a[252:255], v[172:175], v[112:127]
    buffer_load_dwordx4 v12, s[8:11], s56 offen offset:2048 lds
    buffer_load_dword v27, v26, s[40:43], 0 offen sc1
    s_nop 7
    v_pk_mul_f32 v[192:193], v[96:97], s[74:75]
    v_pk_mul_f32 v[194:195], v[98:99], s[74:75]
    s_waitcnt vmcnt(40)
    ds_read_b64_tr_b16 a[0:1], v35 offset:16384
    v_pk_mul_f32 v[196:197], v[100:101], s[74:75]
    v_pk_mul_f32 v[198:199], v[102:103], s[74:75]
    v_exp_f32 v192, v192
    v_exp_f32 v193, v193
    buffer_load_dwordx4 v13, s[8:11], s56 offen offset:3072 lds
    ds_read_b64_tr_b16 a[4:5], v36 offset:16384
    v_exp_f32 v194, v194
    v_exp_f32 v195, v195
    v_exp_f32 v196, v196
    v_exp_f32 v197, v197
    ds_read_b64_tr_b16 a[2:3], v35 offset:17408
    v_exp_f32 v198, v198
    v_exp_f32 v199, v199
    v_pk_add_f32 v[200:201], v[192:193], s[76:77]
    v_pk_add_f32 v[202:203], v[194:195], s[76:77]
    ds_read_b64_tr_b16 a[6:7], v36 offset:17408
    v_pk_add_f32 v[204:205], v[196:197], s[76:77]
    v_pk_add_f32 v[206:207], v[198:199], s[76:77]
    v_pk_fma_f32 v[208:209], v[192:193], v[192:193], v[200:201]
    v_pk_fma_f32 v[210:211], v[194:195], v[194:195], v[202:203]
    ds_read_b64_tr_b16 a[8:9], v35 offset:18432
    ds_read_b64_tr_b16 a[12:13], v36 offset:18432
    ds_read_b64_tr_b16 a[10:11], v35 offset:19456
    ds_read_b64_tr_b16 a[14:15], v36 offset:19456
    s_waitcnt lgkmcnt(0)
    s_add_u32 m0, s58, 147456
    s_add_u32 s56, s79, 327680
    buffer_load_dwordx4 v10, s[8:11], s56 offen offset:0 lds
    s_waitcnt vmcnt(38)
    ds_read_b64_tr_b16 a[16:17], v20 offset:32768
    v_pk_fma_f32 v[212:213], v[196:197], v[196:197], v[204:205]
    v_pk_fma_f32 v[214:215], v[198:199], v[198:199], v[206:207]
    v_rcp_f32 v208, v208
    v_rcp_f32 v209, v209
    ds_read_b64_tr_b16 a[20:21], v21 offset:32768
    v_rcp_f32 v210, v210
    v_rcp_f32 v211, v211
    v_rcp_f32 v212, v212
    v_rcp_f32 v213, v213
    ds_read_b64_tr_b16 a[18:19], v20 offset:33792
    v_rcp_f32 v214, v214
    v_rcp_f32 v215, v215
    v_pk_mul_f32 v[200:201], v[200:201], v[208:209] clamp
    buffer_load_dwordx4 v11, s[8:11], s56 offen offset:1024 lds
    v_pk_mul_f32 v[202:203], v[202:203], v[210:211] clamp
    ds_read_b64_tr_b16 a[22:23], v21 offset:33792
    v_pk_mul_f32 v[204:205], v[204:205], v[212:213] clamp
    v_pk_mul_f32 v[206:207], v[206:207], v[214:215] clamp
    v_pk_mul_f32 v[200:201], v[200:201], v[96:97]
    v_pk_mul_f32 v[202:203], v[202:203], v[98:99]
    ds_read_b64_tr_b16 a[24:25], v20 offset:34816
    v_pk_mul_f32 v[204:205], v[204:205], v[100:101]
    v_pk_mul_f32 v[206:207], v[206:207], v[102:103]
    v_cvt_pk_bf16_f32 v232, v200, v201
    v_cvt_pk_bf16_f32 v233, v202, v203
    ds_read_b64_tr_b16 a[28:29], v21 offset:34816
    v_cvt_pk_bf16_f32 v234, v204, v205
    v_cvt_pk_bf16_f32 v235, v206, v207
    s_add_u32 s67, s67, 118784
    buffer_store_dwordx4 v[232:235], v24, s[32:35], s67 offen offset:0 sc1
    v_pk_mul_f32 v[192:193], v[104:105], s[74:75]
    buffer_load_dwordx4 v12, s[8:11], s56 offen offset:2048 lds
    v_pk_mul_f32 v[194:195], v[106:107], s[74:75]
    ds_read_b64_tr_b16 a[26:27], v20 offset:35840
    v_pk_mul_f32 v[196:197], v[108:109], s[74:75]
    v_pk_mul_f32 v[198:199], v[110:111], s[74:75]
    v_exp_f32 v192, v192
    v_exp_f32 v193, v193
    ds_read_b64_tr_b16 a[30:31], v21 offset:35840
    v_exp_f32 v194, v194
    v_exp_f32 v195, v195
    v_exp_f32 v196, v196
    v_exp_f32 v197, v197
    s_waitcnt vmcnt(37)
    ds_read_b64_tr_b16 a[32:33], v20 offset:49152
    v_exp_f32 v198, v198
    v_exp_f32 v199, v199
    buffer_load_dwordx4 v13, s[8:11], s56 offen offset:3072 lds
    v_pk_add_f32 v[200:201], v[192:193], s[76:77]
    v_pk_add_f32 v[202:203], v[194:195], s[76:77]
    ds_read_b64_tr_b16 a[36:37], v21 offset:49152
    v_pk_add_f32 v[204:205], v[196:197], s[76:77]
    v_pk_add_f32 v[206:207], v[198:199], s[76:77]
    v_pk_fma_f32 v[208:209], v[192:193], v[192:193], v[200:201]
    v_pk_fma_f32 v[210:211], v[194:195], v[194:195], v[202:203]
    ds_read_b64_tr_b16 a[34:35], v20 offset:50176
    v_pk_fma_f32 v[212:213], v[196:197], v[196:197], v[204:205]
    v_pk_fma_f32 v[214:215], v[198:199], v[198:199], v[206:207]
    v_rcp_f32 v208, v208
    v_rcp_f32 v209, v209
    ds_read_b64_tr_b16 a[38:39], v21 offset:50176
    v_rcp_f32 v210, v210
    s_waitcnt lgkmcnt(4)
    s_add_u32 m0, s58, 32768
    s_add_u32 s56, s79, 360448
    buffer_load_dwordx4 v10, s[8:11], s56 offen offset:0 lds
    v_rcp_f32 v211, v211
    v_rcp_f32 v212, v212
    v_rcp_f32 v213, v213
    ds_read_b64_tr_b16 a[40:41], v20 offset:51200
    v_rcp_f32 v214, v214
    v_rcp_f32 v215, v215
    v_pk_mul_f32 v[200:201], v[200:201], v[208:209] clamp
    v_pk_mul_f32 v[202:203], v[202:203], v[210:211] clamp
    ds_read_b64_tr_b16 a[44:45], v21 offset:51200
    v_pk_mul_f32 v[204:205], v[204:205], v[212:213] clamp
    v_pk_mul_f32 v[206:207], v[206:207], v[214:215] clamp
    v_pk_mul_f32 v[200:201], v[200:201], v[104:105]
    v_pk_mul_f32 v[202:203], v[202:203], v[106:107]
    ds_read_b64_tr_b16 a[42:43], v20 offset:52224
    v_pk_mul_f32 v[204:205], v[204:205], v[108:109]
    buffer_load_dwordx4 v11, s[8:11], s56 offen offset:1024 lds
    v_pk_mul_f32 v[206:207], v[206:207], v[110:111]
    v_cvt_pk_bf16_f32 v236, v200, v201
    v_cvt_pk_bf16_f32 v237, v202, v203
    ds_read_b64_tr_b16 a[46:47], v21 offset:52224
    v_cvt_pk_bf16_f32 v238, v204, v205
    v_cvt_pk_bf16_f32 v239, v206, v207
    buffer_store_dwordx4 v[236:239], v24, s[32:35], s67 offen offset:1024 sc1
    s_waitcnt vmcnt(9)
L_arm:
    v_cmp_eq_u32 vcc, 1, v27
    s_nop 0
    s_cmp_eq_u64 vcc, -1
    s_cbranch_scc0 L_arm_slow
L_arm_ok:
    s_mov_b32 exec_hi, 0
    buffer_store_dword v29, v30, s[32:35], s68 offen sc1
    s_mov_b32 exec_hi, -1
    v_pk_mul_f32 v[192:193], v[112:113], s[74:75]
    v_pk_mul_f32 v[194:195], v[114:115], s[74:75]
    ds_read_b64_tr_b16 a[48:49], v20 offset:0
    v_pk_mul_f32 v[196:197], v[116:117], s[74:75]
    v_pk_mul_f32 v[198:199], v[118:119], s[74:75]
    v_exp_f32 v192, v192
    v_exp_f32 v193, v193
    buffer_load_dwordx4 v12, s[8:11], s56 offen offset:2048 lds
    ds_read_b64_tr_b16 a[52:53], v21 offset:0
    v_exp_f32 v194, v194
    v_exp_f32 v195, v195
    v_exp_f32 v196, v196
    v_exp_f32 v197, v197
    ds_read_b64_tr_b16 a[50:51], v20 offset:1024
    v_exp_f32 v198, v198
    v_exp_f32 v199, v199
    v_pk_add_f32 v[200:201], v[192:193], s[76:77]
    v_pk_add_f32 v[202:203], v[194:195], s[76:77]
    ds_read_b64_tr_b16 a[54:55], v21 offset:1024
    v_pk_add_f32 v[204:205], v[196:197], s[76:77]
    v_pk_add_f32 v[206:207], v[198:199], s[76:77]
    v_pk_fma_f32 v[208:209], v[192:193], v[192:193], v[200:201]
    v_pk_fma_f32 v[210:211], v[194:195], v[194:195], v[202:203]
    buffer_load_dwordx4 v13, s[8:11], s56 offen offset:3072 lds
    ds_read_b64_tr_b16 a[56:57], v20 offset:2048
    v_pk_fma_f32 v[212:213], v[196:197], v[196:197], v[204:205]
    v_pk_fma_f32 v[214:215], v[198:199], v[198:199], v[206:207]
    v_rcp_f32 v208, v208
    v_rcp_f32 v209, v209
    ds_read_b64_tr_b16 a[60:61], v21 offset:2048
    v_rcp_f32 v210, v210
    v_rcp_f32 v211, v211
    v_rcp_f32 v212, v212
    v_rcp_f32 v213, v213
    ds_read_b64_tr_b16 a[58:59], v20 offset:3072
    v_rcp_f32 v214, v214
    v_rcp_f32 v215, v215
    v_pk_mul_f32 v[200:201], v[200:201], v[208:209] clamp
    v_pk_mul_f32 v[202:203], v[202:203], v[210:211] clamp
    ds_read_b64_tr_b16 a[62:63], v21 offset:3072
    v_pk_mul_f32 v[204:205], v[204:205], v[212:213] clamp
    v_pk_mul_f32 v[206:207], v[206:207], v[214:215] clamp
    v_pk_mul_f32 v[200:201], v[200:201], v[112:113]
    v_pk_mul_f32 v[202:203], v[202:203], v[114:115]
    v_pk_mul_f32 v[204:205], v[204:205], v[116:117]
    v_pk_mul_f32 v[206:207], v[206:207], v[118:119]
    v_cvt_pk_bf16_f32 v240, v200, v201
    v_cvt_pk_bf16_f32 v241, v202, v203
    v_cvt_pk_bf16_f32 v242, v204, v205
    v_cvt_pk_bf16_f32 v243, v206, v207
    buffer_store_dwordx4 v[240:243], v24, s[32:35], s67 offen offset:2048 sc1
    v_pk_mul_f32 v[192:193], v[120:121], s[74:75]
    v_pk_mul_f32 v[194:195], v[122:123], s[74:75]
    v_pk_mul_f32 v[196:197], v[124:125], s[74:75]
    v_pk_mul_f32 v[198:199], v[126:127], s[74:75]
    v_exp_f32 v192, v192
    v_exp_f32 v193, v193
    v_exp_f32 v194, v194
    v_exp_f32 v195, v195
    v_exp_f32 v196, v196
    v_exp_f32 v197, v197
    v_exp_f32 v198, v198
    v_exp_f32 v199, v199
    v_pk_add_f32 v[200:201], v[192:193], s[76:77]
    v_pk_add_f32 v[202:203], v[194:195], s[76:77]
    v_pk_add_f32 v[204:205], v[196:197], s[76:77]
    v_pk_add_f32 v[206:207], v[198:199], s[76:77]
    v_pk_fma_f32 v[208:209], v[192:193], v[192:193], v[200:201]
    v_pk_fma_f32 v[210:211], v[194:195], v[194:195], v[202:203]
    v_pk_fma_f32 v[212:213], v[196:197], v[196:197], v[204:205]
    v_pk_fma_f32 v[214:215], v[198:199], v[198:199], v[206:207]
    v_rcp_f32 v208, v208
    v_rcp_f32 v209, v209
    v_rcp_f32 v210, v210
    v_rcp_f32 v211, v211
    v_rcp_f32 v212, v212
    v_rcp_f32 v213, v213
    v_rcp_f32 v214, v214
    v_rcp_f32 v215, v215
    v_pk_mul_f32 v[200:201], v[200:201], v[208:209] clamp
    v_pk_mul_f32 v[202:203], v[202:203], v[210:211] clamp
    v_pk_mul_f32 v[204:205], v[204:205], v[212:213] clamp
    v_pk_mul_f32 v[206:207], v[206:207], v[214:215] clamp
    v_pk_mul_f32 v[200:201], v[200:201], v[120:121]
    v_pk_mul_f32 v[202:203], v[202:203], v[122:123]
    v_pk_mul_f32 v[204:205], v[204:205], v[124:125]
    v_pk_mul_f32 v[206:207], v[206:207], v[126:127]
    v_cvt_pk_bf16_f32 v244, v200, v201
    v_cvt_pk_bf16_f32 v245, v202, v203
    v_cvt_pk_bf16_f32 v246, v204, v205
    v_cvt_pk_bf16_f32 v247, v206, v207
    buffer_store_dwordx4 v[244:247], v24, s[32:35], s67 offen offset:3072 sc1
L_enter2:
    s_buffer_load_dword s53, s[36:39], s69 offset:0 glc
    s_buffer_load_dword s59, s[36:39], s69 offset:128 glc
    s_buffer_load_dword s60, s[36:39], s69 offset:256 glc
    s_buffer_load_dword s61, s[36:39], s69 offset:384 glc
    s_buffer_load_dword s44, s[36:39], s69 offset:512 glc
    s_buffer_load_dword s45, s[36:39], s69 offset:640 glc
    s_buffer_load_dword s46, s[36:39], s69 offset:768 glc
    s_waitcnt lgkmcnt(8)
    s_add_u32 m0, s58, 49152
    s_add_u32 s56, s79, 393216
    buffer_load_dwordx4 v10, s[8:11], s56 offen offset:0 lds
    ds_read_b64_tr_b16 a[64:65], v20 offset:16384
    ds_read_b64_tr_b16 a[68:69], v21 offset:16384
    ds_read_b64_tr_b16 a[66:67], v20 offset:17408
    ds_read_b64_tr_b16 a[70:71], v21 offset:17408
    buffer_load_dwordx4 v11, s[8:11], s56 offen offset:1024 lds
    ds_read_b64_tr_b16 a[72:73], v20 offset:18432
    ds_read_b64_tr_b16 a[76:77], v21 offset:18432
    ds_read_b64_tr_b16 a[74:75], v20 offset:19456
    ds_read_b64_tr_b16 a[78:79], v21 offset:19456
    buffer_load_dwordx4 v12, s[8:11], s56 offen offset:2048 lds
    ds_read_b64_tr_b16 a[80:81], v22 offset:0
    ds_read_b64_tr_b16 a[84:85], v23 offset:0
    ds_read_b64_tr_b16 a[82:83], v22 offset:1024
    ds_read_b64_tr_b16 a[86:87], v23 offset:1024
    buffer_load_dwordx4 v13, s[8:11], s56 offen offset:3072 lds
    ds_read_b64_tr_b16 a[88:89], v22 offset:2048
    ds_read_b64_tr_b16 a[92:93], v23 offset:2048
    ds_read_b64_tr_b16 a[90:91], v22 offset:3072
    ds_read_b64_tr_b16 a[94:95], v23 offset:3072
    s_waitcnt lgkmcnt(12)
    s_mov_b32 m0, s58
    s_add_u32 s56, s79, 425984
    buffer_load_dwordx4 v10, s[8:11], s56 offen offset:0 lds
    ds_read_b64_tr_b16 a[96:97], v22 offset:16384
    ds_read_b64_tr_b16 a[100:101], v23 offset:16384
    ds_read_b64_tr_b16 a[98:99], v22 offset:17408
    ds_read_b64_tr_b16 a[102:103], v23 offset:17408
    buffer_load_dwordx4 v11, s[8:11], s56 offen offset:1024 lds
    s_waitcnt vmcnt(6)
    s_add_u32 s68, s68, 118784
    s_mov_b32 exec_hi, 0
    buffer_store_dword v29, v30, s[32:35], s68 offen sc1
    s_mov_b32 exec_hi, -1
    ds_read_b64_tr_b16 a[104:105], v22 offset:18432
    ds_read_b64_tr_b16 a[108:109], v23 offset:18432
    ds_read_b64_tr_b16 a[106:107], v22 offset:19456
    ds_read_b64_tr_b16 a[110:111], v23 offset:19456
    buffer_load_dwordx4 v12, s[8:11], s56 offen offset:2048 lds
    ds_read_b64_tr_b16 a[112:113], v22 offset:32768
    ds_read_b64_tr_b16 a[116:117], v23 offset:32768
    ds_read_b64_tr_b16 a[114:115], v22 offset:33792
    ds_read_b64_tr_b16 a[118:119], v23 offset:33792
    buffer_load_dwordx4 v13, s[8:11], s56 offen offset:3072 lds
    ds_read_b64_tr_b16 a[120:121], v22 offset:34816
    ds_read_b64_tr_b16 a[124:125], v23 offset:34816
    ds_read_b64_tr_b16 a[122:123], v22 offset:35840
    ds_read_b64_tr_b16 a[126:127], v23 offset:35840
L_pollA:
    s_waitcnt lgkmcnt(0)
    s_and_b32 s53, s53, s59
    s_and_b32 s53, s53, s60
    s_and_b32 s53, s53, s61
    s_and_b32 s53, s53, s44
    s_and_b32 s53, s53, s45
    s_and_b32 s53, s53, s46
    s_cbranch_scc0 L_pollA_slow
L_pollA_ok:
    s_add_u32 s78, s70, 0
    buffer_load_dwordx4 v[128:131], v24, s[36:39], s78 offen offset:0 sc1
    ds_read_b64_tr_b16 a[128:129], v22 offset:49152
    ds_read_b64_tr_b16 a[132:133], v23 offset:49152
    ds_read_b64_tr_b16 a[130:131], v22 offset:50176
    ds_read_b64_tr_b16 a[134:135], v23 offset:50176
    ds_read_b64_tr_b16 a[136:137], v22 offset:51200
    ds_read_b64_tr_b16 a[140:141], v23 offset:51200
    buffer_load_dwordx4 v[132:135], v24, s[36:39], s78 offen offset:1024 sc1
    ds_read_b64_tr_b16 a[138:139], v22 offset:52224
    ds_read_b64_tr_b16 a[142:143], v23 offset:52224
    ds_read_b64_tr_b16 a[144:145], v35 offset:0
    ds_read_b64_tr_b16 a[148:149], v36 offset:0
    ds_read_b64_tr_b16 a[146:147], v35 offset:1024
    ds_read_b64_tr_b16 a[150:151], v36 offset:1024
    buffer_load_dwordx4 v[136:139], v24, s[36:39], s78 offen offset:2048 sc1
    ds_read_b64_tr_b16 a[152:153], v35 offset:2048
    ds_read_b64_tr_b16 a[156:157], v36 offset:2048
    ds_read_b64_tr_b16 a[154:155], v35 offset:3072
    ds_read_b64_tr_b16 a[158:159], v36 offset:3072
    ds_read_b64_tr_b16 a[160:161], v35 offset:16384
    ds_read_b64_tr_b16 a[164:165], v36 offset:16384
    buffer_load_dwordx4 v[140:143], v24, s[36:39], s78 offen offset:3072 sc1
    ds_read_b64_tr_b16 a[162:163], v35 offset:17408
    ds_read_b64_tr_b16 a[166:167], v36 offset:17408
    ds_read_b64_tr_b16 a[168:169], v35 offset:18432
    ds_read_b64_tr_b16 a[172:173], v36 offset:18432
    ds_read_b64_tr_b16 a[170:171], v35 offset:19456
    ds_read_b64_tr_b16 a[174:175], v36 offset:19456
    s_add_u32 s78, s70, 4096
    buffer_load_dwordx4 v[144:147], v24, s[36:39], s78 offen offset:0 sc1
    ds_read_b64_tr_b16 a[176:177], v20 offset:32768
    ds_read_b64_tr_b16 a[180:181], v21 offset:32768
    ds_read_b64_tr_b16 a[178:179], v20 offset:33792
    ds_read_b64_tr_b16 a[182:183], v21 offset:33792
    ds_read_b64_tr_b16 a[184:185], v20 offset:34816
    ds_read_b64_tr_b16 a[188:189], v21 offset:34816
    buffer_load_dwordx4 v[148:151], v24, s[36:39], s78 offen offset:1024 sc1
    ds_read_b64_tr_b16 a[186:187], v20 offset:35840
    ds_read_b64_tr_b16 a[190:191], v21 offset:35840
    buffer_load_dwordx4 v[152:155], v24, s[36:39], s78 offen offset:2048 sc1
    s_waitcnt vmcnt(12)
    ds_read_b64_tr_b16 a[192:193], v20 offset:49152
    ds_read_b64_tr_b16 a[196:197], v21 offset:49152
    ds_read_b64_tr_b16 a[194:195], v20 offset:50176
    ds_read_b64_tr_b16 a[198:199], v21 offset:50176
    ds_read_b64_tr_b16 a[200:201], v20 offset:51200
    ds_read_b64_tr_b16 a[204:205], v21 offset:51200
    buffer_load_dwordx4 v[156:159], v24, s[36:39], s78 offen offset:3072 sc1
    ds_read_b64_tr_b16 a[202:203], v20 offset:52224
    ds_read_b64_tr_b16 a[206:207], v21 offset:52224
    s_add_u32 s78, s70, 8192
    buffer_load_dwordx4 v[160:163], v24, s[36:39], s78 offen offset:0 sc1
    s_waitcnt vmcnt(8)
    v_mfma_f32_32x32x16_bf16 v[64:79], a[0:3], v[128:131], 0
    ds_read_b64_tr_b16 a[208:209], v20 offset:0
    ds_read_b64_tr_b16 a[212:213], v21 offset:0
    v_mfma_f32_32x32x16_bf16 v[80:95], a[4:7], v[128:131], 0
    ds_read_b64_tr_b16 a[210:211], v20 offset:1024
    ds_read_b64_tr_b16 a[214:215], v21 offset:1024
    buffer_load_dwordx4 v[164:167], v24, s[36:39], s78 offen offset:1024 sc1
    s_waitcnt vmcnt(8)
    v_mfma_f32_32x32x16_bf16 v[64:79], a[8:11], v[132:135], v[64:79]
    ds_read_b64_tr_b16 a[216:217], v20 offset:2048
    ds_read_b64_tr_b16 a[220:221], v21 offset:2048
    v_mfma_f32_32x32x16_bf16 v[80:95], a[12:15], v[132:135], v[80:95]
    ds_read_b64_tr_b16 a[218:219], v20 offset:3072
    ds_read_b64_tr_b16 a[222:223], v21 offset:3072
    buffer_load_dwordx4 v[168:171], v24, s[36:39], s78 offen offset:2048 sc1
    s_waitcnt vmcnt(8)
    v_mfma_f32_32x32x16_bf16 v[64:79], a[16:19], v[136:139], v[64:79]
    v_mfma_f32_32x32x16_bf16 v[80:95], a[20:23], v[136:139], v[80:95]
    buffer_load_dwordx4 v[172:175], v24, s[36:39], s78 offen offset:3072 sc1
    s_waitcnt vmcnt(8)
    v_mfma_f32_32x32x16_bf16 v[64:79], a[24:27], v[140:143], v[64:79]
    v_mfma_f32_32x32x16_bf16 v[80:95], a[28:31], v[140:143], v[80:95]
    s_add_u32 s78, s70, 12288
    buffer_load_dwordx4 v[176:179], v24, s[36:39], s78 offen offset:0 sc1
    s_waitcnt vmcnt(8)
    v_mfma_f32_32x32x16_bf16 v[64:79], a[32:35], v[144:147], v[64:79]
    v_mfma_f32_32x32x16_bf16 v[80:95], a[36:39], v[144:147], v[80:95]
    buffer_load_dwordx4 v[180:183], v24, s[36:39], s78 offen offset:1024 sc1
    s_waitcnt vmcnt(8)
    v_mfma_f32_32x32x16_bf16 v[64:79], a[40:43], v[148:151], v[64:79]
    v_mfma_f32_32x32x16_bf16 v[80:95], a[44:47], v[148:151], v[80:95]
    buffer_load_dwordx4 v[184:187], v24, s[36:39], s78 offen offset:2048 sc1
    s_waitcnt vmcnt(8)
    v_mfma_f32_32x32x16_bf16 v[64:79], a[48:51], v[152:155], v[64:79]
    v_mfma_f32_32x32x16_bf16 v[80:95], a[52:55], v[152:155], v[80:95]
    buffer_load_dwordx4 v[188:191], v24, s[36:39], s78 offen offset:3072 sc1
    s_waitcnt vmcnt(8)
    v_mfma_f32_32x32x16_bf16 v[64:79], a[56:59], v[156:159], v[64:79]
    v_mfma_f32_32x32x16_bf16 v[80:95], a[60:63], v[156:159], v[80:95]
    s_add_u32 s78, s70, 16384
    buffer_load_dwordx4 v[128:131], v24, s[36:39], s78 offen offset:0 sc1
    s_waitcnt vmcnt(8)
    v_mfma_f32_32x32x16_bf16 v[64:79], a[64:67], v[160:163], v[64:79]
    v_mfma_f32_32x32x16_bf16 v[80:95], a[68:71], v[160:163], v[80:95]
    buffer_load_dwordx4 v[132:135], v24, s[36:39], s78 offen offset:1024 sc1
    s_waitcnt vmcnt(8)
    v_mfma_f32_32x32x16_bf16 v[64:79], a[72:75], v[164:167], v[64:79]
    v_mfma_f32_32x32x16_bf16 v[80:95], a[76:79], v[164:167], v[80:95]
    buffer_load_dwordx4 v[136:139], v24, s[36:39], s78 offen offset:2048 sc1
    s_waitcnt vmcnt(8)
    v_mfma_f32_32x32x16_bf16 v[64:79], a[80:83], v[168:171], v[64:79]
    v_mfma_f32_32x32x16_bf16 v[80:95], a[84:87], v[168:171], v[80:95]
    buffer_load_dwordx4 v[140:143], v24, s[36:39], s78 offen offset:3072 sc1
    s_waitcnt vmcnt(8)
    v_mfma_f32_32x32x16_bf16 v[64:79], a[88:91], v[172:175], v[64:79]
    v_mfma_f32_32x32x16_bf16 v[80:95], a[92:95], v[172:175], v[80:95]
    s_add_u32 s69, s69, 118784
    s_buffer_load_dword s53, s[36:39], s69 offset:0 glc
    s_buffer_load_dword s59, s[36:39], s69 offset:128 glc
    s_buffer_load_dword s60, s[36:39], s69 offset:256 glc
    s_buffer_load_dword s61, s[36:39], s69 offset:384 glc
    s_buffer_load_dword s44, s[36:39], s69 offset:512 glc
    s_buffer_load_dword s45, s[36:39], s69 offset:640 glc
    s_buffer_load_dword s46, s[36:39], s69 offset:768 glc
    s_add_u32 s78, s70, 20480
    buffer_load_dwordx4 v[144:147], v24, s[36:39], s78 offen offset:0 sc1
    s_waitcnt vmcnt(8)
    v_mfma_f32_32x32x16_bf16 v[64:79], a[96:99], v[176:179], v[64:79]
    v_mfma_f32_32x32x16_bf16 v[80:95], a[100:103], v[176:179], v[80:95]
    buffer_load_dwordx4 v[148:151], v24, s[36:39], s78 offen offset:1024 sc1
    s_waitcnt vmcnt(8)
    v_mfma_f32_32x32x16_bf16 v[64:79], a[104:107], v[180:183], v[64:79]
    v_mfma_f32_32x32x16_bf16 v[80:95], a[108:111], v[180:183], v[80:95]
    buffer_load_dwordx4 v[152:155], v24, s[36:39], s78 offen offset:2048 sc1
    s_waitcnt vmcnt(8)
    v_mfma_f32_32x32x16_bf16 v[64:79], a[112:115], v[184:187], v[64:79]
    v_mfma_f32_32x32x16_bf16 v[80:95], a[116:119], v[184:187], v[80:95]
    buffer_load_dwordx4 v[156:159], v24, s[36:39], s78 offen offset:3072 sc1
    s_waitcnt vmcnt(8)
    v_mfma_f32_32x32x16_bf16 v[64:79], a[120:123], v[188:191], v[64:79]
    v_mfma_f32_32x32x16_bf16 v[80:95], a[124:127], v[188:191], v[80:95]
    s_add_u32 s78, s70, 24576
    buffer_load_dwordx4 v[160:163], v24, s[36:39], s78 offen offset:0 sc1
    s_waitcnt vmcnt(8)
    s_waitcnt lgkmcnt(12)
    v_mfma_f32_32x32x16_bf16 v[64:79], a[128:131], v[128:131], v[64:79]
    v_mfma_f32_32x32x16_bf16 v[80:95], a[132:135], v[128:131], v[80:95]
    buffer_load_dwordx4 v[164:167], v24, s[36:39], s78 offen offset:1024 sc1
    s_waitcnt vmcnt(8)
    v_mfma_f32_32x32x16_bf16 v[64:79], a[136:139], v[132:135], v[64:79]
    v_mfma_f32_32x32x16_bf16 v[80:95], a[140:143], v[132:135], v[80:95]
    buffer_load_dwordx4 v[168:171], v24, s[36:39], s78 offen offset:2048 sc1
    s_waitcnt vmcnt(8)
    v_mfma_f32_32x32x16_bf16 v[64:79], a[144:147], v[136:139], v[64:79]
    v_mfma_f32_32x32x16_bf16 v[80:95], a[148:151], v[136:139], v[80:95]
    buffer_load_dwordx4 v[172:175], v24, s[36:39], s78 offen offset:3072 sc1
    s_waitcnt vmcnt(8)
    v_mfma_f32_32x32x16_bf16 v[64:79], a[152:155], v[140:143], v[64:79]
    v_mfma_f32_32x32x16_bf16 v[80:95], a[156:159], v[140:143], v[80:95]
L_pollB:
    s_waitcnt lgkmcnt(0)
    s_and_b32 s53, s53, s59
    s_and_b32 s53, s53, s60
    s_and_b32 s53, s53, s61
    s_and_b32 s53, s53, s44
    s_and_b32 s53, s53, s45
    s_and_b32 s53, s53, s46
    s_cbranch_scc0 L_pollB_slow
L_pollB_ok:
    s_add_u32 s78, s70, 118784
    buffer_load_dwordx4 v[176:179], v24, s[36:39], s78 offen offset:0 sc1
    s_waitcnt vmcnt(8)
    v_mfma_f32_32x32x16_bf16 v[64:79], a[160:163], v[144:147], v[64:79]
    v_mfma_f32_32x32x16_bf16 v[80:95], a[164:167], v[144:147], v[80:95]
    buffer_load_dwordx4 v[180:183], v24, s[36:39], s78 offen offset:1024 sc1
    s_waitcnt vmcnt(8)
    v_mfma_f32_32x32x16_bf16 v[64:79], a[168:171], v[148:151], v[64:79]
    v_mfma_f32_32x32x16_bf16 v[80:95], a[172:175], v[148:151], v[80:95]
    buffer_load_dwordx4 v[184:187], v24, s[36:39], s78 offen offset:2048 sc1
    s_waitcnt vmcnt(8)
    v_mfma_f32_32x32x16_bf16 v[64:79], a[176:179], v[152:155], v[64:79]
    v_mfma_f32_32x32x16_bf16 v[80:95], a[180:183], v[152:155], v[80:95]
    buffer_load_dwordx4 v[188:191], v24, s[36:39], s78 offen offset:3072 sc1
    s_waitcnt vmcnt(8)
    v_mfma_f32_32x32x16_bf16 v[64:79], a[184:187], v[156:159], v[64:79]
    v_mfma_f32_32x32x16_bf16 v[80:95], a[188:191], v[156:159], v[80:95]
    s_add_u32 s78, s70, 122880
    buffer_load_dwordx4 v[128:131], v24, s[36:39], s78 offen offset:0 sc1
    s_waitcnt vmcnt(8)
    v_mfma_f32_32x32x16_bf16 v[64:79], a[192:195], v[160:163], v[64:79]
    v_mfma_f32_32x32x16_bf16 v[80:95], a[196:199], v[160:163], v[80:95]
    buffer_load_dwordx4 v[132:135], v24, s[36:39], s78 offen offset:1024 sc1
    s_waitcnt vmcnt(8)
    v_mfma_f32_32x32x16_bf16 v[64:79], a[200:203], v[164:167], v[64:79]
    v_mfma_f32_32x32x16_bf16 v[80:95], a[204:207], v[164:167], v[80:95]
    buffer_load_dwordx4 v[136:139], v24, s[36:39], s78 offen offset:2048 sc1
    s_waitcnt vmcnt(8)
    v_mfma_f32_32x32x16_bf16 v[64:79], a[208:211], v[168:171], v[64:79]
    v_mfma_f32_32x32x16_bf16 v[80:95], a[212:215], v[168:171], v[80:95]
    buffer_load_dwordx4 v[140:143], v24, s[36:39], s78 offen offset:3072 sc1
    v_xor_b32 v39, 32, v32
    v_xor_b32 v40, 64, v32
    v_xor_b32 v41, 96, v32
    s_mov_b64 s[28:29], s[64:65]
    s_mov_b32 s30, 2097152
    v_xor_b32 v42, 16, v33
    s_waitcnt vmcnt(8)
    v_mfma_f32_32x32x16_bf16 v[64:79], a[216:219], v[172:175], v[64:79]
    v_mfma_f32_32x32x16_bf16 v[80:95], a[220:223], v[172:175], v[80:95]
    s_add_u32 s78, s70, 126976
    buffer_load_dwordx4 v[144:147], v24, s[36:39], s78 offen offset:0 sc1
    s_waitcnt vmcnt(8)
    v_mfma_f32_32x32x16_bf16 v[96:111], a[0:3], v[176:179], 0
    v_mfma_f32_32x32x16_bf16 v[112:127], a[4:7], v[176:179], 0
    buffer_load_dwordx4 v[148:151], v24, s[36:39], s78 offen offset:1024 sc1
    s_waitcnt vmcnt(8)
    v_mfma_f32_32x32x16_bf16 v[96:111], a[8:11], v[180:183], v[96:111]
    v_mfma_f32_32x32x16_bf16 v[112:127], a[12:15], v[180:183], v[112:127]
    buffer_load_dwordx4 v[152:155], v24, s[36:39], s78 offen offset:2048 sc1
    s_waitcnt vmcnt(8)
    v_mfma_f32_32x32x16_bf16 v[96:111], a[16:19], v[184:187], v[96:111]
    v_mfma_f32_32x32x16_bf16 v[112:127], a[20:23], v[184:187], v[112:127]
    buffer_load_dwordx4 v[156:159], v24, s[36:39], s78 offen offset:3072 sc1
    s_waitcnt vmcnt(8)
    v_mfma_f32_32x32x16_bf16 v[96:111], a[24:27], v[188:191], v[96:111]
    v_mfma_f32_32x32x16_bf16 v[112:127], a[28:31], v[188:191], v[112:127]
    s_add_u32 s78, s70, 131072
    buffer_load_dwordx4 v[160:163], v24, s[36:39], s78 offen offset:0 sc1
    ds_write_b128 v32, v[64:67] offset:0
    s_waitcnt vmcnt(8)
    v_mfma_f32_32x32x16_bf16 v[96:111], a[32:35], v[128:131], v[96:111]
    v_mfma_f32_32x32x16_bf16 v[112:127], a[36:39], v[128:131], v[112:127]
    buffer_load_dwordx4 v[164:167], v24, s[36:39], s78 offen offset:1024 sc1
    ds_write_b128 v39, v[68:71] offset:0
    s_waitcnt vmcnt(8)
    v_mfma_f32_32x32x16_bf16 v[96:111], a[40:43], v[132:135], v[96:111]
    v_mfma_f32_32x32x16_bf16 v[112:127], a[44:47], v[132:135], v[112:127]
    buffer_load_dwordx4 v[168:171], v24, s[36:39], s78 offen offset:2048 sc1
    ds_write_b128 v40, v[72:75] offset:0
    s_waitcnt vmcnt(8)
    v_mfma_f32_32x32x16_bf16 v[96:111], a[48:51], v[136:139], v[96:111]
    v_mfma_f32_32x32x16_bf16 v[112:127], a[52:55], v[136:139], v[112:127]
    buffer_load_dwordx4 v[172:175], v24, s[36:39], s78 offen offset:3072 sc1
    ds_write_b128 v41, v[76:79] offset:0
    s_waitcnt vmcnt(8)
    v_mfma_f32_32x32x16_bf16 v[96:111], a[56:59], v[140:143], v[96:111]
    v_mfma_f32_32x32x16_bf16 v[112:127], a[60:63], v[140:143], v[112:127]
    s_add_u32 s78, s70, 135168
    buffer_load_dwordx4 v[176:179], v24, s[36:39], s78 offen offset:0 sc1
    ds_write_b128 v32, v[80:83] offset:128
    s_waitcnt vmcnt(8)
    v_mfma_f32_32x32x16_bf16 v[96:111], a[64:67], v[144:147], v[96:111]
    v_mfma_f32_32x32x16_bf16 v[112:127], a[68:71], v[144:147], v[112:127]
    buffer_load_dwordx4 v[180:183], v24, s[36:39], s78 offen offset:1024 sc1
    ds_write_b128 v39, v[84:87] offset:128
    s_waitcnt vmcnt(8)
    v_mfma_f32_32x32x16_bf16 v[96:111], a[72:75], v[148:151], v[96:111]
    v_mfma_f32_32x32x16_bf16 v[112:127], a[76:79], v[148:151], v[112:127]
    buffer_load_dwordx4 v[184:187], v24, s[36:39], s78 offen offset:2048 sc1
    ds_write_b128 v40, v[88:91] offset:128
    s_waitcnt vmcnt(8)
    v_mfma_f32_32x32x16_bf16 v[96:111], a[80:83], v[152:155], v[96:111]
    v_mfma_f32_32x32x16_bf16 v[112:127], a[84:87], v[152:155], v[112:127]
    buffer_load_dwordx4 v[188:191], v24, s[36:39], s78 offen offset:3072 sc1
    ds_write_b128 v41, v[92:95] offset:128
    s_waitcnt vmcnt(8)
    v_mfma_f32_32x32x16_bf16 v[96:111], a[88:91], v[156:159], v[96:111]
    v_mfma_f32_32x32x16_bf16 v[112:127], a[92:95], v[156:159], v[112:127]
    s_add_u32 s78, s70, 139264
    buffer_load_dwordx4 v[128:131], v24, s[36:39], s78 offen offset:0 sc1
    s_waitcnt vmcnt(8)
    v_mfma_f32_32x32x16_bf16 v[96:111], a[96:99], v[160:163], v[96:111]
    v_mfma_f32_32x32x16_bf16 v[112:127], a[100:103], v[160:163], v[112:127]
    buffer_load_dwordx4 v[132:135], v24, s[36:39], s78 offen offset:1024 sc1
    s_waitcnt vmcnt(8)
    v_mfma_f32_32x32x16_bf16 v[96:111], a[104:107], v[164:167], v[96:111]
    v_mfma_f32_32x32x16_bf16 v[112:127], a[108:111], v[164:167], v[112:127]
    buffer_load_dwordx4 v[136:139], v24, s[36:39], s78 offen offset:2048 sc1
    s_waitcnt vmcnt(8)
    v_mfma_f32_32x32x16_bf16 v[96:111], a[112:115], v[168:171], v[96:111]
    v_mfma_f32_32x32x16_bf16 v[112:127], a[116:119], v[168:171], v[112:127]
    buffer_load_dwordx4 v[140:143], v24, s[36:39], s78 offen offset:3072 sc1
    s_waitcnt lgkmcnt(0)
    s_barrier
    s_waitcnt vmcnt(8)
    v_mfma_f32_32x32x16_bf16 v[96:111], a[120:123], v[172:175], v[96:111]
    ds_read_b128 v[192:195], v33 offset:0
    ds_read_b128 v[196:199], v42 offset:0
    ds_read_b128 v[200:203], v33 offset:4096
    v_mfma_f32_32x32x16_bf16 v[112:127], a[124:127], v[172:175], v[112:127]
    ds_read_b128 v[204:207], v42 offset:4096
    ds_read_b128 v[208:211], v33 offset:8192
    ds_read_b128 v[212:215], v42 offset:8192
    s_add_u32 s78, s70, 143360
    buffer_load_dwordx4 v[144:147], v24, s[36:39], s78 offen offset:0 sc1
    s_waitcnt vmcnt(8)
    v_mfma_f32_32x32x16_bf16 v[96:111], a[128:131], v[176:179], v[96:111]
    ds_read_b128 v[216:219], v33 offset:12288
    ds_read_b128 v[220:223], v42 offset:12288
    v_mfma_f32_32x32x16_bf16 v[112:127], a[132:135], v[176:179], v[112:127]
    buffer_load_dwordx4 v[148:151], v24, s[36:39], s78 offen offset:1024 sc1
    s_waitcnt vmcnt(8)
    v_mfma_f32_32x32x16_bf16 v[96:111], a[136:139], v[180:183], v[96:111]
    v_mfma_f32_32x32x16_bf16 v[112:127], a[140:143], v[180:183], v[112:127]
    buffer_load_dwordx4 v[152:155], v24, s[36:39], s78 offen offset:2048 sc1
    s_waitcnt lgkmcnt(0)
    s_waitcnt vmcnt(8)
    v_mfma_f32_32x32x16_bf16 v[96:111], a[144:147], v[184:187], v[96:111]
    v_add_f32 v192, v192, v200
    v_add_f32 v193, v193, v201
    v_add_f32 v194, v194, v202
    v_mfma_f32_32x32x16_bf16 v[112:127], a[148:151], v[184:187], v[112:127]
    v_add_f32 v195, v195, v203
    v_add_f32 v196, v196, v204
    v_add_f32 v197, v197, v205
    buffer_load_dwordx4 v[156:159], v24, s[36:39], s78 offen offset:3072 sc1
    s_waitcnt vmcnt(8)
    v_mfma_f32_32x32x16_bf16 v[96:111], a[152:155], v[188:191], v[96:111]
    v_add_f32 v198, v198, v206
    v_add_f32 v199, v199, v207
    v_add_f32 v208, v208, v216
    v_mfma_f32_32x32x16_bf16 v[112:127], a[156:159], v[188:191], v[112:127]
    v_add_f32 v209, v209, v217
    v_add_f32 v210, v210, v218
    v_add_f32 v211, v211, v219
    s_waitcnt vmcnt(7)
    v_mfma_f32_32x32x16_bf16 v[96:111], a[160:163], v[128:131], v[96:111]
    v_add_f32 v212, v212, v220
    v_add_f32 v213, v213, v221
    v_add_f32 v214, v214, v222
    v_mfma_f32_32x32x16_bf16 v[112:127], a[164:167], v[128:131], v[112:127]
    v_add_f32 v215, v215, v223
    v_add_f32 v192, v192, v208
    v_add_f32 v193, v193, v209
    s_waitcnt vmcnt(6)
    v_mfma_f32_32x32x16_bf16 v[96:111], a[168:171], v[132:135], v[96:111]
    v_add_f32 v194, v194, v210
    v_add_f32 v195, v195, v211
    v_add_f32 v196, v196, v212
    v_mfma_f32_32x32x16_bf16 v[112:127], a[172:175], v[132:135], v[112:127]
    v_add_f32 v197, v197, v213
    v_add_f32 v198, v198, v214
    v_add_f32 v199, v199, v215
    s_waitcnt vmcnt(5)
    v_mfma_f32_32x32x16_bf16 v[96:111], a[176:179], v[136:139], v[96:111]
    v_cvt_pk_bf16_f32 v200, v192, v193
    v_cvt_pk_bf16_f32 v201, v194, v195
    v_cvt_pk_bf16_f32 v202, v196, v197
    s_waitcnt vmcnt(4)
    v_mfma_f32_32x32x16_bf16 v[96:111], a[184:187], v[140:143], v[96:111]
    v_cvt_pk_bf16_f32 v203, v198, v199
    buffer_store_dwordx4 v[200:203], v34, s[28:31], s72 offen nt
    s_add_u32 s72, s72, 32768
    s_waitcnt vmcnt(4)
    v_mfma_f32_32x32x16_bf16 v[96:111], a[192:195], v[144:147], v[96:111]
    s_waitcnt vmcnt(3)
    v_mfma_f32_32x32x16_bf16 v[96:111], a[200:203], v[148:151], v[96:111]
    s_waitcnt vmcnt(2)
    v_mfma_f32_32x32x16_bf16 v[96:111], a[208:211], v[152:155], v[96:111]
    s_waitcnt vmcnt(1)
    v_mfma_f32_32x32x16_bf16 v[96:111], a[216:219], v[156:159], v[96:111]
    v_mfma_f32_32x32x16_bf16 v[112:127], a[180:183], v[136:139], v[112:127]
    s_nop 4
    v_mfma_f32_32x32x16_bf16 v[112:127], a[188:191], v[140:143], v[112:127]
    s_nop 4
    ds_write_b128 v32, v[96:99] offset:32768
    v_mfma_f32_32x32x16_bf16 v[112:127], a[196:199], v[144:147], v[112:127]
    ds_write_b128 v39, v[100:103] offset:32768
    v_mfma_f32_32x32x16_bf16 v[112:127], a[204:207], v[148:151], v[112:127]
    ds_write_b128 v40, v[104:107] offset:32768
    v_mfma_f32_32x32x16_bf16 v[112:127], a[212:215], v[152:155], v[112:127]
    ds_write_b128 v41, v[108:111] offset:32768
    v_mfma_f32_32x32x16_bf16 v[112:127], a[220:223], v[156:159], v[112:127]
    s_nop 11
    ds_write_b128 v32, v[112:115] offset:32896
    ds_write_b128 v39, v[116:119] offset:32896
    ds_write_b128 v40, v[120:123] offset:32896
    ds_write_b128 v41, v[124:127] offset:32896
    s_waitcnt lgkmcnt(0)
    s_barrier
    ds_read_b128 v[160:163], v33 offset:32768
    ds_read_b128 v[164:167], v42 offset:32768
    ds_read_b128 v[168:171], v33 offset:36864
    ds_read_b128 v[172:175], v42 offset:36864
    ds_read_b128 v[176:179], v33 offset:40960
    ds_read_b128 v[180:183], v42 offset:40960
    ds_read_b128 v[184:187], v33 offset:45056
    ds_read_b128 v[188:191], v42 offset:45056
    s_waitcnt lgkmcnt(4)
    v_pk_add_f32 v[160:161], v[160:161], v[168:169]
    v_pk_add_f32 v[162:163], v[162:163], v[170:171]
    v_pk_add_f32 v[164:165], v[164:165], v[172:173]
    v_pk_add_f32 v[166:167], v[166:167], v[174:175]
    s_waitcnt lgkmcnt(0)
    v_pk_add_f32 v[176:177], v[176:177], v[184:185]
    v_pk_add_f32 v[178:179], v[178:179], v[186:187]
    v_pk_add_f32 v[180:181], v[180:181], v[188:189]
    v_pk_add_f32 v[182:183], v[182:183], v[190:191]
    v_pk_add_f32 v[160:161], v[160:161], v[176:177]
    v_pk_add_f32 v[162:163], v[162:163], v[178:179]
    v_pk_add_f32 v[164:165], v[164:165], v[180:181]
    v_pk_add_f32 v[166:167], v[166:167], v[182:183]
    v_cvt_pk_bf16_f32 v168, v160, v161
    v_cvt_pk_bf16_f32 v169, v162, v163
    v_cvt_pk_bf16_f32 v170, v164, v165
    v_cvt_pk_bf16_f32 v171, v166, v167
    buffer_store_dwordx4 v[168:171], v34, s[28:31], s72 offen nt
L_end:
    s_endpgm
L_arm_slow:
    s_add_u32 s71, s71, 1
    s_cmp_ge_u32 s71, 200000
    s_cbranch_scc1 L_arm_ok
    buffer_load_dword v27, v26, s[40:43], 0 offen sc1
    s_waitcnt vmcnt(0)
    s_branch L_arm
L_pollA_slow:
    s_add_u32 s71, s71, 1
    s_cmp_ge_u32 s71, 200000
    s_cbranch_scc1 L_pollA_ok
    s_buffer_load_dword s53, s[36:39], s69 offset:0 glc
    s_buffer_load_dword s59, s[36:39], s69 offset:128 glc
    s_buffer_load_dword s60, s[36:39], s69 offset:256 glc
    s_buffer_load_dword s61, s[36:39], s69 offset:384 glc
    s_buffer_load_dword s44, s[36:39], s69 offset:512 glc
    s_buffer_load_dword s45, s[36:39], s69 offset:640 glc
    s_buffer_load_dword s46, s[36:39], s69 offset:768 glc
    s_branch L_pollA
L_pollB_slow:
    s_add_u32 s71, s71, 1
    s_cmp_ge_u32 s71, 200000
    s_cbranch_scc1 L_pollB_ok
    s_buffer_load_dword s53, s[36:39], s69 offset:0 glc
    s_buffer_load_dword s59, s[36:39], s69 offset:128 glc
    s_buffer_load_dword s60, s[36:39], s69 offset:256 glc
    s_buffer_load_dword s61, s[36:39], s69 offset:384 glc
    s_buffer_load_dword s44, s[36:39], s69 offset:512 glc
    s_buffer_load_dword s45, s[36:39], s69 offset:640 glc
    s_buffer_load_dword s46, s[36:39], s69 offset:768 glc
    s_branch L_pollB
L_spare:
    s_and_b32 s46, s2, 1
    s_lshr_b32 s49, s2, 6
    s_and_b32 s44, s2, 6
    s_lshl1_add_u32 s44, s44, s49
    s_lshl_b32 s58, s3, 12
    v_lshrrev_b32 v38, 3, v1
    v_lshrrev_b32 v39, 4, v1
    v_and_b32 v40, 7, v1
    v_lshlrev_b32 v56, 7, v1
    s_and_b32 s73, s2, 7
    s_mul_i32 s59, s49, 56
    s_add_u32 s59, s59, s3
    s_lshl_b32 s59, s59, 13
    s_mul_i32 s61, s73, 7
    s_lshr_b32 s61, s61, 2
    s_lshl_b32 s61, s61, 15
    s_add_u32 s61, s61, s59
    s_mov_b32 s22, 2097152
    s_and_b32 s62, s3, 2
    s_add_u32 s62, s62, s3
    s_lshl3_add_u32 s54, s44, s62
    s_add_u32 s54, s54, 2
    s_lshl_b32 s54, s54, 14
    s_waitcnt lgkmcnt(0)
    s_mov_b64 s[64:65], s[10:11]
    s_mov_b32 s10, 1835008
    s_mov_b32 s11, s23
    s_xor_b32 s62, s46, 0
    s_lshl_b32 s62, s62, 13
    s_add_u32 s62, s62, s54
    buffer_load_dword v62, v56, s[20:23], s62 offen
    v_lshrrev_b32 v43, 5, v1
    v_and_b32 v41, 1, v39
    v_bfe_u32 v45, v1, 2, 2
    v_and_b32 v42, 3, v1
    v_lshlrev_b32 v42, 3, v42
    v_lshl_add_u32 v42, v41, 5, v42
    s_and_b32 s50, s3, 1
    s_lshr_b32 s51, s3, 1
    s_mov_b32 s31, s23
    s_mov_b64 s[40:41], s[12:13]
    s_mov_b64 s[32:33], s[14:15]
    s_mov_b64 s[36:37], s[14:15]
    s_mov_b32 s34, 7602176
    s_mov_b32 s35, s23
    s_mov_b32 s38, s34
    s_mov_b32 s39, s23
    s_movk_i32 s42, 256
    s_mov_b32 s43, s23
    s_and_b32 s73, s2, 7
    s_xor_b32 s19, s47, 4
    s_lshl2_add_u32 s48, s73, s49
    v_lshlrev_b32 v46, 2, v41
    v_xor_b32 v46, v40, v46
    v_lshlrev_b32 v46, 4, v46
    v_lshl_add_u32 v10, v38, 10, v46
    v_add_u32 v11, 7168, v10
    v_add_u32 v12, 14336, v10
    v_add_u32 v13, 21504, v10
    v_lshl_add_u32 v47, v43, 2, v45
    v_lshl_add_u32 v47, v47, 7, v42
    v_bfe_u32 v44, v1, 3, 1
    v_lshl_add_u32 v47, v44, 6, v47
    v_add_u32 v20, s58, v47
    v_xor_b32 v21, 64, v20
    v_add_u32 v22, 65536, v20
    v_add_u32 v23, 65536, v21
    v_add_u32 v35, 131072, v20
    v_add_u32 v36, 131072, v21
    v_lshlrev_b32 v24, 4, v1
    v_mov_b32 v29, 1
    v_lshlrev_b32 v30, 2, v1
    s_lshl1_add_u32 s62, s44, s46
    s_lshl_b32 s62, s62, 2
    s_and_b32 s63, s48, 30
    s_add_u32 s63, s63, s51
    s_lshl_b32 s63, s63, 2
    s_sub_u32 s63, s63, s62
    v_mul_lo_u32 v26, v43, s63
    v_add_u32 v26, s62, v26
    v_and_b32 v46, 15, v1
    v_lshl_add_u32 v46, v46, 8, s58
    v_lshl_add_u32 v46, v41, 14, v46
    v_xor_b32 v47, v40, v43
    v_lshl_add_u32 v32, v47, 4, v46
    s_lshl_b32 s62, s51, 14
    s_lshl_b32 s63, s50, 11
    s_add_u32 s62, s62, s63
    v_lshl_add_u32 v46, v38, 8, s62
    v_lshlrev_b32 v47, 1, v40
    v_xor_b32 v47, v47, v38
    v_lshl_add_u32 v33, v47, 4, v46
    v_lshlrev_b32 v46, 4, v40
    v_lshl_add_u32 v34, v38, 10, v46
    s_mul_i32 s79, s3, 3584
    s_add_u32 s79, s79, s19
    s_lshl_b32 s79, s79, 7
    s_mul_i32 s62, s48, 237568
    s_mul_i32 s69, s3, 896
    s_add_u32 s69, s69, s62
    s_add_u32 s69, s69, 114688
    s_mul_i32 s70, s3, 28672
    s_add_u32 s70, s70, s62
    s_lshl3_add_u32 s72, s48, s3
    s_lshl_b32 s72, s72, 6
    s_add_u32 s72, s72, s19
    s_lshl_b32 s72, s72, 7
    s_mov_b32 s71, 0
    s_mov_b32 s68, 0
    s_cmp_lg_u32 s3, 0
    s_cbranch_scc1 L_spare2
    v_and_b32 v50, 15, v1
    v_min_u32 v50, 13, v50
    v_lshlrev_b32 v50, 7, v50
    s_mov_b32 s62, 118784
    v_mul_lo_u32 v51, v39, s62
    v_add_u32 v50, v50, v51
    s_mul_i32 s62, s44, 475136
    s_mul_i32 s63, s46, 1792
    s_add_u32 s62, s62, s63
    s_add_u32 s62, s62, 114688
    v_mov_b32 v52, 0
    buffer_store_dword v52, v50, s[32:35], s62 offen sc1
L_spare2:
    s_add_u32 s62, s61, 0
    buffer_load_dword v62, v56, s[8:11], s62 offen
    s_cmp_lg_u32 s3, 0
    s_cbranch_scc1 L_spare3
    s_waitcnt vmcnt(1)
    s_mov_b64 exec, 1
    buffer_store_dword v29, v26, s[40:43], 0 offen sc1
    s_mov_b64 exec, -1
L_spare3:
    s_add_u32 s62, s61, 32768
    buffer_load_dword v62, v56, s[8:11], s62 offen
    s_xor_b32 s62, s46, 1
    s_lshl_b32 s62, s62, 13
    s_add_u32 s62, s62, s54
    buffer_load_dword v62, v56, s[20:23], s62 offen
    s_mov_b32 s34, 0
    s_add_u32 m0, s58, 147456
    s_add_u32 s56, s79, 0
    buffer_load_dwordx4 v10, s[8:11], s56 offen offset:0 lds
    buffer_load_dwordx4 v11, s[8:11], s56 offen offset:1024 lds
    buffer_load_dwordx4 v12, s[8:11], s56 offen offset:2048 lds
    buffer_load_dwordx4 v13, s[8:11], s56 offen offset:3072 lds
    s_add_u32 m0, s58, 32768
    s_add_u32 s56, s79, 32768
    buffer_load_dwordx4 v10, s[8:11], s56 offen offset:0 lds
    buffer_load_dwordx4 v11, s[8:11], s56 offen offset:1024 lds
    buffer_load_dwordx4 v12, s[8:11], s56 offen offset:2048 lds
    buffer_load_dwordx4 v13, s[8:11], s56 offen offset:3072 lds
    s_add_u32 m0, s58, 49152
    s_add_u32 s56, s79, 65536
    buffer_load_dwordx4 v10, s[8:11], s56 offen offset:0 lds
    buffer_load_dwordx4 v11, s[8:11], s56 offen offset:1024 lds
    buffer_load_dwordx4 v12, s[8:11], s56 offen offset:2048 lds
    buffer_load_dwordx4 v13, s[8:11], s56 offen offset:3072 lds
    s_mov_b32 m0, s58
    s_add_u32 s56, s79, 98304
    buffer_load_dwordx4 v10, s[8:11], s56 offen offset:0 lds
    buffer_load_dwordx4 v11, s[8:11], s56 offen offset:1024 lds
    buffer_load_dwordx4 v12, s[8:11], s56 offen offset:2048 lds
    buffer_load_dwordx4 v13, s[8:11], s56 offen offset:3072 lds
    s_add_u32 m0, s58, 16384
    s_add_u32 s56, s79, 131072
    buffer_load_dwordx4 v10, s[8:11], s56 offen offset:0 lds
    buffer_load_dwordx4 v11, s[8:11], s56 offen offset:1024 lds
    buffer_load_dwordx4 v12, s[8:11], s56 offen offset:2048 lds
    buffer_load_dwordx4 v13, s[8:11], s56 offen offset:3072 lds
    s_add_u32 m0, s58, 65536
    s_add_u32 s56, s79, 163840
    buffer_load_dwordx4 v10, s[8:11], s56 offen offset:0 lds
    buffer_load_dwordx4 v11, s[8:11], s56 offen offset:1024 lds
    buffer_load_dwordx4 v12, s[8:11], s56 offen offset:2048 lds
    buffer_load_dwordx4 v13, s[8:11], s56 offen offset:3072 lds
    s_add_u32 m0, s58, 81920
    s_add_u32 s56, s79, 196608
    buffer_load_dwordx4 v10, s[8:11], s56 offen offset:0 lds
    buffer_load_dwordx4 v11, s[8:11], s56 offen offset:1024 lds
    buffer_load_dwordx4 v12, s[8:11], s56 offen offset:2048 lds
    buffer_load_dwordx4 v13, s[8:11], s56 offen offset:3072 lds
    s_add_u32 m0, s58, 98304
    s_add_u32 s56, s79, 229376
    buffer_load_dwordx4 v10, s[8:11], s56 offen offset:0 lds
    buffer_load_dwordx4 v11, s[8:11], s56 offen offset:1024 lds
    buffer_load_dwordx4 v12, s[8:11], s56 offen offset:2048 lds
    buffer_load_dwordx4 v13, s[8:11], s56 offen offset:3072 lds
    s_add_u32 m0, s58, 114688
    s_add_u32 s56, s79, 262144
    buffer_load_dwordx4 v10, s[8:11], s56 offen offset:0 lds
    buffer_load_dwordx4 v11, s[8:11], s56 offen offset:1024 lds
    buffer_load_dwordx4 v12, s[8:11], s56 offen offset:2048 lds
    buffer_load_dwordx4 v13, s[8:11], s56 offen offset:3072 lds
    s_add_u32 m0, s58, 131072
    s_add_u32 s56, s79, 294912
    buffer_load_dwordx4 v10, s[8:11], s56 offen offset:0 lds
    buffer_load_dwordx4 v11, s[8:11], s56 offen offset:1024 lds
    buffer_load_dwordx4 v12, s[8:11], s56 offen offset:2048 lds
    buffer_load_dwordx4 v13, s[8:11], s56 offen offset:3072 lds
    s_waitcnt vmcnt(36)
    ds_read_b64_tr_b16 a[0:1], v35 offset:16384
    ds_read_b64_tr_b16 a[4:5], v36 offset:16384
    ds_read_b64_tr_b16 a[2:3], v35 offset:17408
    ds_read_b64_tr_b16 a[6:7], v36 offset:17408
    ds_read_b64_tr_b16 a[8:9], v35 offset:18432
    ds_read_b64_tr_b16 a[12:13], v36 offset:18432
    ds_read_b64_tr_b16 a[10:11], v35 offset:19456
    ds_read_b64_tr_b16 a[14:15], v36 offset:19456
    s_waitcnt lgkmcnt(0)
    s_add_u32 m0, s58, 147456
    s_add_u32 s56, s79, 327680
    buffer_load_dwordx4 v10, s[8:11], s56 offen offset:0 lds
    buffer_load_dwordx4 v11, s[8:11], s56 offen offset:1024 lds
    buffer_load_dwordx4 v12, s[8:11], s56 offen offset:2048 lds
    buffer_load_dwordx4 v13, s[8:11], s56 offen offset:3072 lds
    s_waitcnt vmcnt(36)
    ds_read_b64_tr_b16 a[16:17], v20 offset:32768
    ds_read_b64_tr_b16 a[20:21], v21 offset:32768
    ds_read_b64_tr_b16 a[18:19], v20 offset:33792
    ds_read_b64_tr_b16 a[22:23], v21 offset:33792
    ds_read_b64_tr_b16 a[24:25], v20 offset:34816
    ds_read_b64_tr_b16 a[28:29], v21 offset:34816
    ds_read_b64_tr_b16 a[26:27], v20 offset:35840
    ds_read_b64_tr_b16 a[30:31], v21 offset:35840
    s_waitcnt lgkmcnt(0)
    s_add_u32 m0, s58, 32768
    s_add_u32 s56, s79, 360448
    buffer_load_dwordx4 v10, s[8:11], s56 offen offset:0 lds
    buffer_load_dwordx4 v11, s[8:11], s56 offen offset:1024 lds
    buffer_load_dwordx4 v12, s[8:11], s56 offen offset:2048 lds
    buffer_load_dwordx4 v13, s[8:11], s56 offen offset:3072 lds
    buffer_load_dword v27, v26, s[40:43], 0 offen sc1
    s_waitcnt vmcnt(37)
    ds_read_b64_tr_b16 a[32:33], v20 offset:49152
    ds_read_b64_tr_b16 a[36:37], v21 offset:49152
    ds_read_b64_tr_b16 a[34:35], v20 offset:50176
    ds_read_b64_tr_b16 a[38:39], v21 offset:50176
    ds_read_b64_tr_b16 a[40:41], v20 offset:51200
    ds_read_b64_tr_b16 a[44:45], v21 offset:51200
    ds_read_b64_tr_b16 a[42:43], v20 offset:52224
    ds_read_b64_tr_b16 a[46:47], v21 offset:52224
    s_waitcnt vmcnt(33)
    ds_read_b64_tr_b16 a[48:49], v20 offset:0
    ds_read_b64_tr_b16 a[52:53], v21 offset:0
    ds_read_b64_tr_b16 a[50:51], v20 offset:1024
    ds_read_b64_tr_b16 a[54:55], v21 offset:1024
    ds_read_b64_tr_b16 a[56:57], v20 offset:2048
    ds_read_b64_tr_b16 a[60:61], v21 offset:2048
    ds_read_b64_tr_b16 a[58:59], v20 offset:3072
    ds_read_b64_tr_b16 a[62:63], v21 offset:3072
    s_waitcnt lgkmcnt(0)
L_arm2:
    s_waitcnt vmcnt(0)
    v_cmp_eq_u32 vcc, 1, v27
    s_add_u32 s71, s71, 1
    s_cmp_eq_u64 vcc, -1
    s_cbranch_scc1 L_enter2
    s_cmp_ge_u32 s71, 200000
    s_cbranch_scc1 L_enter2
    buffer_load_dword v27, v26, s[40:43], 0 offen sc1
    s_branch L_arm2
L_codeend:
    .fill (16384-(L_codeend-L_pcref))/4, 4, 0xbf810000
.section .rodata,"a"
.p2align 6
.amdhsa_kernel standalone__dense_activation_mish__prompt_kernel
  .amdhsa_next_free_vgpr 512
  .amdhsa_next_free_sgpr 102
  .amdhsa_accum_offset 256
  .amdhsa_group_segment_fixed_size 0
  .amdhsa_kernarg_size 56
  .amdhsa_user_sgpr_count 2
  .amdhsa_user_sgpr_kernarg_segment_ptr 1
  .amdhsa_system_sgpr_workgroup_id_x 1
.end_amdhsa_kernel
```
